```python
import torch

def _softmax(x, axis=-1):
    return torch.softmax(x, dim=axis)
def _gelu(x):
    return torch.nn.functional.gelu(x, approximate="tanh")
def _silu(x):
    return torch.nn.functional.silu(x)
def _sigmoid(x):
    return torch.sigmoid(x)
def _layernorm(x, axis=-1, eps=1e-5):
    m = x.mean(dim=axis, keepdim=True)
    v = x.var(dim=axis, keepdim=True, unbiased=False)
    return (x - m) / torch.sqrt(v + eps)
def _scatter_add(tgt, idx, src, axis=0):
    return tgt.clone().index_add_(axis, idx, src)
def _segment_sum(src, seg, n):
    out = torch.zeros((n,) + src.shape[1:], dtype=src.dtype)
    return out.index_add_(0, seg, src)
def _pad(x, pw):
    flat = tuple(v for pair in reversed(pw) for v in pair)
    return torch.nn.functional.pad(x, flat)

kernel_name = 'parallel_sum__ssm_conv_s4d__mixer_channel_mlp__prompt'

def setup_inputs():

    _w = (lambda a: (lambda t: t.to(torch.bfloat16) if t.is_floating_point() else t)(torch.as_tensor(a)))
    def _A_setup():
        Bsz, L, D, N = 1, 2048, 512, 128
        return {
            "u": _w((lambda *s: torch.randn(*s, dtype=torch.bfloat16) * 0.05)(Bsz, L, D)),
            "log_A_real": _w((lambda *s: torch.randn(*s, dtype=torch.bfloat16) * 3.2)(D, N) * 0.5),
            "A_imag": _w((lambda *s: torch.randn(*s, dtype=torch.bfloat16) * 0.05)(D, N) * 3.14),
            "C_real": _w((lambda *s: torch.randn(*s, dtype=torch.bfloat16) * 0.1)(D, N) / N ** 0.5),
            "C_imag": _w((lambda *s: torch.randn(*s, dtype=torch.bfloat16) * 0.2)(D, N) / N ** 0.5),
            "log_dt": _w((lambda *s: torch.randn(*s, dtype=torch.bfloat16) * 0.05)(D) * 0.5 - 4.0),
            "D_skip": _w((lambda *s: torch.randn(*s, dtype=torch.bfloat16) * 0.05)(D)),
        }
    _A_in = _A_setup()

    def _B_setup():
        B, S, D, F = 1, 2048, 512, 1792
        return {
            "x": _w((lambda *s: torch.randn(*s, dtype=torch.bfloat16) * 0.05)(B, S, D)),
            "w1": _w((lambda *s: torch.randn(*s, dtype=torch.bfloat16) * 1.6)(D, F) * (D ** -0.5)),
            "b1": _w((lambda *s: torch.randn(*s, dtype=torch.bfloat16) * 0.8)(F)),
            "w2": _w((lambda *s: torch.randn(*s, dtype=torch.bfloat16) * 0.05)(F, D) * (F ** -0.5)),
            "b2": _w((lambda *s: torch.randn(*s, dtype=torch.bfloat16) * 0.05)(D)),
        }
    _B_in = _B_setup()

    return {
        "A_u": _A_in["u"],
        "A_log_A_real": _A_in["log_A_real"],
        "A_A_imag": _A_in["A_imag"],
        "A_C_real": _A_in["C_real"],
        "A_C_imag": _A_in["C_imag"],
        "A_log_dt": _A_in["log_dt"],
        "A_D_skip": _A_in["D_skip"],
        "B_x": _B_in["x"],
        "B_w1": _B_in["w1"],
        "B_b1": _B_in["b1"],
        "B_w2": _B_in["w2"],
        "B_b2": _B_in["b2"],
    }

def reference(A_u, A_log_A_real, A_A_imag, A_C_real, A_C_imag, A_log_dt, A_D_skip, B_x, B_w1, B_b1, B_w2, B_b2):
    def _A_ref(u, log_A_real, A_imag, C_real, C_imag, log_dt, D_skip):
        L = u.shape[1]
        dt = torch.exp(log_dt)
        A = -torch.exp(log_A_real) + 1j * A_imag
        C = (C_real + 1j * C_imag) * dt[:, None]
        pos = (lambda x, dt: x.to(dt))(torch.arange(L), log_dt.dtype)
        P = torch.exp((A * dt[:, None])[:, :, None] * pos[None, None, :])
        K = 2.0 * torch.einsum("dn,dnl->dl", C, P).real
        L2 = 2 * L
        u_t = (lambda x, *d: x.permute(*d))(u, 0, 2, 1)
        Kf = (lambda x, *a, **k: torch.fft.rfft(x.float(), *a, **k))(K, L2)
        Uf = (lambda x, *a, **k: torch.fft.rfft(x.float(), *a, **k))(u_t, L2)
        y = (lambda x, *a, **k: torch.fft.irfft(x, *a, **k).to(torch.bfloat16))(Uf * Kf[None, :, :], L2)[:, :, :L]
        y = (lambda x, *d: x.permute(*d))(y, 0, 2, 1)
        return y + u * D_skip[None, None, :]

    def _B_ref(x, w1, b1, w2, b2):
        y = _layernorm(x, axis=-1)
        h = _gelu(torch.einsum("bsd,df->bsf", y, w1) + b1)
        return torch.einsum("bsf,fd->bsd", h, w2) + b2

    x = A_u
    xn = _layernorm(x, axis=-1)
    return x + _A_ref(xn, A_log_A_real, A_A_imag, A_C_real, A_C_imag, A_log_dt, A_D_skip) + _B_ref(xn, B_w1, B_b1, B_w2, B_b2)
```

```asm
; @launch grid=(256,1,1) block=(512,1,1) lds=161664
.amdgcn_target "amdgcn-amd-amdhsa--gfx950"
.text
.globl parallel_sum__ssm_conv_s4d__mixer_channel_mlp__prompt_kernel
.p2align 8
.type parallel_sum__ssm_conv_s4d__mixer_channel_mlp__prompt_kernel,@function
parallel_sum__ssm_conv_s4d__mixer_channel_mlp__prompt_kernel:
    s_cmp_ge_u32 s2, 256
    s_cbranch_scc1 Lend1
    s_load_dwordx16 s[4:19], s[0:1], 0
    s_load_dwordx8 s[20:27], s[0:1], 64
    s_load_dwordx4 s[28:31], s[0:1], 96
    s_load_dwordx2 s[32:33], s[0:1], 112
    v_lshrrev_b32 v1, 6, v0
    v_and_b32 v0, 63, v0
    v_readfirstlane_b32 s3, v1
    s_cmp_ge_u32 s3, 4
    s_cbranch_scc1 Lswave
    s_and_b32 s58, s2, 7
    s_lshr_b32 s59, s2, 3
    s_setprio 2
    s_cmp_ge_u32 s59, 28
    s_cbranch_scc1 Laux
    s_mul_i32 s60, s59, 37
    s_lshr_b32 s60, s60, 8
    s_mul_i32 s61, s60, 7
    s_sub_u32 s61, s59, s61
    s_lshr_b32 s52, s58, 1
    s_lshl_b32 s52, s52, 2
    s_add_u32 s52, s52, s60
    s_and_b32 s53, s58, 1
    s_mul_i32 s53, s53, 7
    s_add_u32 s53, s53, s61
    s_lshl_b32 s62, s60, 1
    s_lshl_b32 s55, s52, 17
    s_lshl_b32 s96, s53, 8
    s_add_u32 s54, s55, 1024
    s_lshl_b32 s60, s62, 7
    s_add_u32 s92, s55, s60
    s_mul_i32 s60, s62, 229376
    s_add_u32 s93, s96, s60
    s_lshl_b32 s97, s3, 12
    v_lshrrev_b32 v56, 3, v0
    v_lshrrev_b32 v57, 4, v0
    v_and_b32 v58, 7, v0
    v_xor_b32 v59, v58, v57
    v_lshlrev_b32 v56, 10, v56
    s_lshl_b32 s60, s3, 15
    v_add_u32 v56, s60, v56
    v_lshl_add_u32 v16, v59, 4, v56
    v_xor_b32 v59, 4, v59
    v_lshl_add_u32 v17, v59, 4, v56
    v_add_u32 v17, 7168, v17
    v_add_u32 v18, 14336, v16
    v_add_u32 v19, 14336, v17
    v_and_b32 v58, 15, v0
    v_lshlrev_b32 v59, 2, v57
    v_xor_b32 v58, v58, v59
    s_lshl_b32 s60, s3, 4
    v_add_u32 v59, s60, v57
    s_movk_i32 s61, 3584
    v_mul_lo_u32 v59, v59, s61
    v_lshl_add_u32 v20, v58, 4, v59
    v_add_u32 v21, 13312, v20
    v_add_u32 v22, 26624, v20
    v_add_u32 v23, 39936, v20
    s_waitcnt lgkmcnt(0)
    s_mov_b32 s36, s4
    s_mov_b32 s37, s5
    s_mov_b32 s38, 2097152
    s_mov_b32 s39, 0x20000
    s_mov_b32 s40, s20
    s_mov_b32 s41, s21
    s_mov_b32 s42, 1835008
    s_mov_b32 s43, 0x20000
    s_mov_b32 s18, s92
    s_mov_b32 s19, s93
    s_add_u32 m0, s97, 0
    s_nop 0
    buffer_load_dwordx4 v16, s[36:39], s18 offen offset:0 lds
    buffer_load_dwordx4 v17, s[36:39], s18 offen offset:1024 lds
    buffer_load_dwordx4 v18, s[36:39], s18 offen offset:2048 lds
    buffer_load_dwordx4 v19, s[36:39], s18 offen offset:3072 lds
    s_add_u32 m0, s97, 16384
    s_add_u32 s18, s18, 128
    buffer_load_dwordx4 v20, s[40:43], s19 offen offset:0 lds
    buffer_load_dwordx4 v21, s[40:43], s19 offen offset:1024 lds
    buffer_load_dwordx4 v22, s[40:43], s19 offen offset:2048 lds
    buffer_load_dwordx4 v23, s[40:43], s19 offen offset:3072 lds
    s_add_u32 s19, s19, 229376
    s_cmp_eq_u32 s18, s54
    s_cselect_b32 s18, s55, s18
    s_cselect_b32 s19, s96, s19
    s_add_u32 m0, s97, 32768
    s_nop 0
    buffer_load_dwordx4 v16, s[36:39], s18 offen offset:0 lds
    buffer_load_dwordx4 v17, s[36:39], s18 offen offset:1024 lds
    buffer_load_dwordx4 v18, s[36:39], s18 offen offset:2048 lds
    buffer_load_dwordx4 v19, s[36:39], s18 offen offset:3072 lds
    s_add_u32 m0, s97, 49152
    s_add_u32 s18, s18, 128
    buffer_load_dwordx4 v20, s[40:43], s19 offen offset:0 lds
    buffer_load_dwordx4 v21, s[40:43], s19 offen offset:1024 lds
    buffer_load_dwordx4 v22, s[40:43], s19 offen offset:2048 lds
    buffer_load_dwordx4 v23, s[40:43], s19 offen offset:3072 lds
    s_add_u32 s19, s19, 229376
    s_cmp_eq_u32 s18, s54
    s_cselect_b32 s18, s55, s18
    s_cselect_b32 s19, s96, s19
    s_add_u32 m0, s97, 65536
    s_nop 0
    buffer_load_dwordx4 v16, s[36:39], s18 offen offset:0 lds
    buffer_load_dwordx4 v17, s[36:39], s18 offen offset:1024 lds
    buffer_load_dwordx4 v18, s[36:39], s18 offen offset:2048 lds
    buffer_load_dwordx4 v19, s[36:39], s18 offen offset:3072 lds
    s_add_u32 m0, s97, 81920
    s_add_u32 s18, s18, 128
    buffer_load_dwordx4 v20, s[40:43], s19 offen offset:0 lds
    buffer_load_dwordx4 v21, s[40:43], s19 offen offset:1024 lds
    buffer_load_dwordx4 v22, s[40:43], s19 offen offset:2048 lds
    buffer_load_dwordx4 v23, s[40:43], s19 offen offset:3072 lds
    s_add_u32 s19, s19, 229376
    s_cmp_eq_u32 s18, s54
    s_cselect_b32 s18, s55, s18
    s_cselect_b32 s19, s96, s19
    s_load_dword s34, s[32:33], 0
    s_mov_b32 s44, s32
    s_mov_b32 s45, s33
    s_mov_b32 s46, 20971520
    s_mov_b32 s47, 0x20000
    s_lshr_b32 s60, s59, 3
    s_lshl_b32 s56, s58, 2
    s_add_u32 s56, s56, s60
    s_add_u32 s57, s59, 0
    s_and_b32 s57, s57, 7
    s_lshl_b32 s98, s3, 13
    s_lshl_b32 s60, s56, 2
    s_add_u32 s60, s60, s3
    s_lshl_b32 s60, s60, 7
    s_add_u32 s101, s60, 65536
    s_mov_b32 s48, s24
    s_mov_b32 s49, s25
    s_mov_b32 s50, 1835008
    s_mov_b32 s51, 0x20000
    s_mul_i32 s61, s3, 7
    s_mul_i32 s62, s56, 224
    s_add_u32 s62, s62, s61
    s_mul_i32 s61, s3, 28
    s_lshl_b32 s62, s62, 10
    s_add_u32 s62, s62, 10485760
    s_lshl_b32 s61, s61, 14
    s_lshl_b32 s60, s57, 7
    s_add_u32 s61, s61, s60
    s_lshr_b32 s95, s59, 3
    s_lshl_b32 s95, s95, 31
    s_and_b32 s95, s95, 7
    s_add_u32 s60, s57, s95
    s_mul_i32 s95, s60, 37
    s_lshr_b32 s95, s95, 8
    s_mul_i32 s95, s95, 7
    s_sub_u32 s60, s60, s95
    s_lshl_b32 s95, s60, 10
    s_add_u32 s4, s62, s95
    s_lshl_b32 s95, s60, 16
    s_add_u32 s11, s61, s95
    s_add_u32 s60, s60, 1
    s_cmp_eq_u32 s60, 7
    s_cselect_b32 s60, 0, s60
    s_lshl_b32 s95, s60, 10
    s_add_u32 s5, s62, s95
    s_lshl_b32 s95, s60, 16
    s_add_u32 s12, s61, s95
    s_add_u32 s60, s60, 1
    s_cmp_eq_u32 s60, 7
    s_cselect_b32 s60, 0, s60
    s_lshl_b32 s95, s60, 10
    s_add_u32 s6, s62, s95
    s_lshl_b32 s95, s60, 16
    s_add_u32 s13, s61, s95
    s_add_u32 s60, s60, 1
    s_cmp_eq_u32 s60, 7
    s_cselect_b32 s60, 0, s60
    s_lshl_b32 s95, s60, 10
    s_add_u32 s7, s62, s95
    s_lshl_b32 s95, s60, 16
    s_add_u32 s14, s61, s95
    s_add_u32 s60, s60, 1
    s_cmp_eq_u32 s60, 7
    s_cselect_b32 s60, 0, s60
    s_lshl_b32 s95, s60, 10
    s_add_u32 s8, s62, s95
    s_lshl_b32 s95, s60, 16
    s_add_u32 s15, s61, s95
    s_add_u32 s60, s60, 1
    s_cmp_eq_u32 s60, 7
    s_cselect_b32 s60, 0, s60
    s_lshl_b32 s95, s60, 10
    s_add_u32 s9, s62, s95
    s_lshl_b32 s95, s60, 16
    s_add_u32 s16, s61, s95
    s_add_u32 s60, s60, 1
    s_cmp_eq_u32 s60, 7
    s_cselect_b32 s60, 0, s60
    s_lshl_b32 s95, s60, 10
    s_add_u32 s10, s62, s95
    s_lshl_b32 s95, s60, 16
    s_add_u32 s17, s61, s95
    v_lshlrev_b32 v1, 4, v0
    v_add_u32 v2, 114688, v1
    s_lshr_b32 s60, s3, 1
    s_mul_i32 s60, s60, 114688
    v_add_u32 v14, s60, v1
    s_sub_u32 s60, 114688, s60
    v_add_u32 v15, s60, v1
    v_and_b32 v13, 31, v0
    v_lshlrev_b32 v13, 2, v13
    v_lshrrev_b32 v56, 3, v0
    v_and_b32 v57, 7, v0
    v_bfe_u32 v58, v0, 4, 1
    v_lshlrev_b32 v59, 2, v58
    v_xor_b32 v59, v59, v57
    v_lshlrev_b32 v3, 10, v56
    v_lshl_add_u32 v3, v59, 4, v3
    v_add_u32 v4, 7168, v3
    v_lshrrev_b32 v56, 5, v0
    v_bfe_u32 v57, v0, 2, 2
    v_lshl_add_u32 v56, v56, 2, v57
    v_bfe_u32 v57, v0, 3, 1
    v_lshlrev_b32 v57, 2, v57
    v_lshl_add_u32 v57, v58, 1, v57
    v_bfe_u32 v58, v0, 1, 1
    v_add_u32 v57, v57, v58
    v_lshlrev_b32 v56, 7, v56
    v_lshl_add_u32 v56, v57, 4, v56
    v_and_b32 v58, 1, v0
    v_lshl_add_u32 v56, v58, 3, v56
    s_and_b32 s60, s3, 1
    s_lshl_b32 s60, s60, 6
    v_xor_b32 v56, s60, v56
    v_add_u32 v5, s98, v56
    v_xor_b32 v6, 64, v5
    v_add_u32 v7, 0x10000, v5
    v_add_u32 v8, 0x10000, v6
    v_mov_b32 v9, 152064
    v_mov_b32 v10, 1
    s_lshl_b32 s60, s2, 13
    s_lshl_b32 s61, s3, 11
    s_add_u32 s60, s60, s61
    v_lshlrev_b32 v61, 7, v0
    s_mov_b64 exec, 0xffff
    buffer_load_dword v62, v61, s[48:51], s60 offen
    s_mov_b64 exec, -1
    v_and_b32 v56, 31, v0
    v_lshrrev_b32 v57, 5, v0
    v_bfe_u32 v58, v0, 1, 3
    v_xor_b32 v57, v57, v58
    s_lshr_b32 s60, s3, 1
    s_lshl_b32 s60, s60, 13
    v_lshlrev_b32 v60, 4, v56
    v_lshlrev_b32 v56, 7, v56
    v_add_u32 v56, s60, v56
    v_lshl_add_u32 v26, v57, 4, v56
    v_xor_b32 v27, 32, v26
    v_xor_b32 v28, 64, v26
    v_xor_b32 v29, 96, v26
    v_lshrrev_b32 v56, 5, v0
    v_bfe_u32 v57, v0, 2, 2
    v_lshl_add_u32 v56, v56, 3, v57
    v_lshlrev_b32 v56, 8, v56
    v_bfe_u32 v58, v0, 4, 1
    v_bfe_u32 v59, v0, 1, 1
    v_lshl_add_u32 v58, v58, 1, v59
    s_and_b32 s60, s3, 1
    s_lshl_b32 s60, s60, 3
    v_add_u32 v58, s60, v58
    v_lshlrev_b32 v57, 2, v57
    v_xor_b32 v58, v58, v57
    v_and_b32 v59, 1, v0
    v_lshl_add_u32 v56, v59, 3, v56
    v_add_u32 v56, 16384, v56
    v_lshl_add_u32 v24, v58, 4, v56
    v_xor_b32 v25, 64, v24
    v_add_u32 v30, 0x10000, v24
    v_add_u32 v31, 0x10000, v25
    v_add_u32 v32, 0x10000, v26
    v_add_u32 v33, 0x10000, v27
    v_add_u32 v34, 0x10000, v28
    v_add_u32 v35, 0x10000, v29
    s_lshl_b32 s60, s52, 2
    s_and_b32 s61, s3, 2
    s_add_u32 s60, s60, s61
    s_lshl_b32 s92, s60, 9
    s_add_u32 s92, s92, 32768
    s_mul_i32 s62, s60, 112
    s_lshl_b32 s61, s53, 1
    s_and_b32 s95, s3, 1
    s_add_u32 s61, s61, s95
    s_lshl_b32 s93, s61, 10
    s_add_u32 s93, s93, 131072
    s_lshl_b32 s95, s61, 0
    s_add_u32 s62, s62, s95
    s_lshl_b32 s62, s62, 10
    s_add_u32 s99, s62, 10485760
    s_mul_i32 s62, s61, 37
    s_lshr_b32 s62, s62, 8
    s_mul_i32 s95, s62, 7
    s_sub_u32 s61, s61, s95
    s_lshl_b32 s60, s60, 1
    s_add_u32 s60, s60, s62
    s_lshl_b32 s60, s60, 7
    s_lshl_b32 s61, s61, 2
    s_add_u32 s60, s60, s61
    s_add_u32 s100, s60, 65536
    s_waitcnt lgkmcnt(0)
    s_add_u32 s35, s34, 0x9E3779B9
    v_mov_b32 v12, s35
    s_barrier
    s_waitcnt vmcnt(17)
    s_mov_b64 exec, 1
    ds_add_u32 v9, v10 offset:0
    s_mov_b64 exec, -1
    s_mov_b32 s94, 65536
Lw_1001:
    ds_read_b32 v11, v9 offset:0
    s_waitcnt lgkmcnt(0)
    v_cmp_gt_u32 vcc, 4, v11
    s_cbranch_vccz Lwd_1002
    s_sub_u32 s94, s94, 1
    s_cbranch_scc0 Lw_1001
Lwd_1002:
    ds_read_b64_tr_b16 v[128:129], v24 offset:0
    ds_read_b64_tr_b16 v[130:131], v24 offset:1024
    ds_read_b64_tr_b16 v[132:133], v25 offset:0
    ds_read_b64_tr_b16 v[134:135], v25 offset:1024
    ds_read_b128 v[160:163], v26 offset:0
    ds_read_b128 v[164:167], v26 offset:4096
    ds_read_b64_tr_b16 v[136:137], v24 offset:4096
    ds_read_b64_tr_b16 v[138:139], v24 offset:5120
    ds_read_b64_tr_b16 v[140:141], v25 offset:4096
    ds_read_b64_tr_b16 v[142:143], v25 offset:5120
    ds_read_b128 v[168:171], v27 offset:0
    ds_read_b128 v[172:175], v27 offset:4096
    ds_read_b64_tr_b16 v[144:145], v24 offset:8192
    ds_read_b64_tr_b16 v[146:147], v24 offset:9216
    ds_read_b64_tr_b16 v[148:149], v25 offset:8192
    ds_read_b64_tr_b16 v[150:151], v25 offset:9216
    ds_read_b128 v[176:179], v28 offset:0
    ds_read_b128 v[180:183], v28 offset:4096
    ds_read_b64_tr_b16 v[152:153], v24 offset:12288
    ds_read_b64_tr_b16 v[154:155], v24 offset:13312
    ds_read_b64_tr_b16 v[156:157], v25 offset:12288
    ds_read_b64_tr_b16 v[158:159], v25 offset:13312
    ds_read_b128 v[184:187], v29 offset:0
    ds_read_b128 v[188:191], v29 offset:4096
    s_waitcnt vmcnt(9) lgkmcnt(0)
    s_mov_b64 exec, 1
    ds_add_u32 v9, v10 offset:0
    s_mov_b64 exec, -1
    ds_read_b32 v11, v9 offset:0
    v_mfma_f32_32x32x16_bf16 v[64:79], v[128:131], v[160:163], 0
    v_mfma_f32_32x32x16_bf16 v[80:95], v[132:135], v[160:163], 0
    s_waitcnt lgkmcnt(0)
    v_cmp_gt_u32 vcc, 8, v11
    s_cbranch_vccnz Lgs_1003
Lgb_1004:
    s_add_u32 m0, s97, 0
    s_nop 0
    buffer_load_dwordx4 v16, s[36:39], s18 offen offset:0 lds
    ds_read_b64_tr_b16 v[192:193], v24 offset:32768
    ds_read_b64_tr_b16 v[194:195], v24 offset:33792
    ds_read_b64_tr_b16 v[196:197], v25 offset:32768
    v_mfma_f32_32x32x16_bf16 v[96:111], v[128:131], v[164:167], 0
    ds_read_b64_tr_b16 v[198:199], v25 offset:33792
    ds_read_b128 v[224:227], v26 offset:32768
    ds_read_b128 v[228:231], v26 offset:36864
    v_mfma_f32_32x32x16_bf16 v[112:127], v[132:135], v[164:167], 0
    buffer_load_dwordx4 v17, s[36:39], s18 offen offset:1024 lds
    ds_read_b64_tr_b16 v[200:201], v24 offset:36864
    ds_read_b64_tr_b16 v[202:203], v24 offset:37888
    ds_read_b64_tr_b16 v[204:205], v25 offset:36864
    v_mfma_f32_32x32x16_bf16 v[64:79], v[136:139], v[168:171], v[64:79]
    ds_read_b64_tr_b16 v[206:207], v25 offset:37888
    ds_read_b128 v[232:235], v27 offset:32768
    ds_read_b128 v[236:239], v27 offset:36864
    v_mfma_f32_32x32x16_bf16 v[80:95], v[140:143], v[168:171], v[80:95]
    buffer_load_dwordx4 v18, s[36:39], s18 offen offset:2048 lds
    ds_read_b64_tr_b16 v[208:209], v24 offset:40960
    ds_read_b64_tr_b16 v[210:211], v24 offset:41984
    ds_read_b64_tr_b16 v[212:213], v25 offset:40960
    v_mfma_f32_32x32x16_bf16 v[96:111], v[136:139], v[172:175], v[96:111]
    ds_read_b64_tr_b16 v[214:215], v25 offset:41984
    ds_read_b128 v[240:243], v28 offset:32768
    ds_read_b128 v[244:247], v28 offset:36864
    v_mfma_f32_32x32x16_bf16 v[112:127], v[140:143], v[172:175], v[112:127]
    buffer_load_dwordx4 v19, s[36:39], s18 offen offset:3072 lds
    ds_read_b64_tr_b16 v[216:217], v24 offset:45056
    ds_read_b64_tr_b16 v[218:219], v24 offset:46080
    ds_read_b64_tr_b16 v[220:221], v25 offset:45056
    v_mfma_f32_32x32x16_bf16 v[64:79], v[144:147], v[176:179], v[64:79]
    ds_read_b64_tr_b16 v[222:223], v25 offset:46080
    ds_read_b128 v[248:251], v29 offset:32768
    ds_read_b128 v[252:255], v29 offset:36864
    v_mfma_f32_32x32x16_bf16 v[80:95], v[148:151], v[176:179], v[80:95]
    s_add_u32 m0, s97, 16384
    s_add_u32 s18, s18, 128
    buffer_load_dwordx4 v20, s[40:43], s19 offen offset:0 lds
    v_mfma_f32_32x32x16_bf16 v[96:111], v[144:147], v[180:183], v[96:111]
    v_mfma_f32_32x32x16_bf16 v[112:127], v[148:151], v[180:183], v[112:127]
    buffer_load_dwordx4 v21, s[40:43], s19 offen offset:1024 lds
    v_mfma_f32_32x32x16_bf16 v[64:79], v[152:155], v[184:187], v[64:79]
    s_waitcnt lgkmcnt(0) vmcnt(7)
    s_mov_b64 exec, 1
    ds_add_u32 v9, v10 offset:0
    s_mov_b64 exec, -1
    v_mfma_f32_32x32x16_bf16 v[80:95], v[156:159], v[184:187], v[80:95]
    buffer_load_dwordx4 v22, s[40:43], s19 offen offset:2048 lds
    v_mfma_f32_32x32x16_bf16 v[96:111], v[152:155], v[188:191], v[96:111]
    v_mfma_f32_32x32x16_bf16 v[112:127], v[156:159], v[188:191], v[112:127]
    buffer_load_dwordx4 v23, s[40:43], s19 offen offset:3072 lds
    s_add_u32 s19, s19, 229376
    s_cmp_eq_u32 s18, s54
    s_cselect_b32 s18, s55, s18
    s_cselect_b32 s19, s96, s19
    ds_read_b32 v11, v9 offset:0
    v_mfma_f32_32x32x16_bf16 v[64:79], v[192:195], v[224:227], v[64:79]
    v_mfma_f32_32x32x16_bf16 v[80:95], v[196:199], v[224:227], v[80:95]
    s_waitcnt lgkmcnt(0)
    v_cmp_gt_u32 vcc, 12, v11
    s_cbranch_vccnz Lgs_1006
Lgb_1007:
    s_add_u32 m0, s97, 32768
    s_nop 0
    buffer_load_dwordx4 v16, s[36:39], s18 offen offset:0 lds
    ds_read_b64_tr_b16 v[128:129], v30 offset:0
    ds_read_b64_tr_b16 v[130:131], v30 offset:1024
    ds_read_b64_tr_b16 v[132:133], v31 offset:0
    v_mfma_f32_32x32x16_bf16 v[96:111], v[192:195], v[228:231], v[96:111]
    ds_read_b64_tr_b16 v[134:135], v31 offset:1024
    ds_read_b128 v[160:163], v32 offset:0
    ds_read_b128 v[164:167], v32 offset:4096
    v_mfma_f32_32x32x16_bf16 v[112:127], v[196:199], v[228:231], v[112:127]
    buffer_load_dwordx4 v17, s[36:39], s18 offen offset:1024 lds
    ds_read_b64_tr_b16 v[136:137], v30 offset:4096
    ds_read_b64_tr_b16 v[138:139], v30 offset:5120
    ds_read_b64_tr_b16 v[140:141], v31 offset:4096
    v_mfma_f32_32x32x16_bf16 v[64:79], v[200:203], v[232:235], v[64:79]
    ds_read_b64_tr_b16 v[142:143], v31 offset:5120
    ds_read_b128 v[168:171], v33 offset:0
    ds_read_b128 v[172:175], v33 offset:4096
    v_mfma_f32_32x32x16_bf16 v[80:95], v[204:207], v[232:235], v[80:95]
    buffer_load_dwordx4 v18, s[36:39], s18 offen offset:2048 lds
    ds_read_b64_tr_b16 v[144:145], v30 offset:8192
    ds_read_b64_tr_b16 v[146:147], v30 offset:9216
    ds_read_b64_tr_b16 v[148:149], v31 offset:8192
    v_mfma_f32_32x32x16_bf16 v[96:111], v[200:203], v[236:239], v[96:111]
    ds_read_b64_tr_b16 v[150:151], v31 offset:9216
    ds_read_b128 v[176:179], v34 offset:0
    ds_read_b128 v[180:183], v34 offset:4096
    v_mfma_f32_32x32x16_bf16 v[112:127], v[204:207], v[236:239], v[112:127]
    buffer_load_dwordx4 v19, s[36:39], s18 offen offset:3072 lds
    ds_read_b64_tr_b16 v[152:153], v30 offset:12288
    ds_read_b64_tr_b16 v[154:155], v30 offset:13312
    ds_read_b64_tr_b16 v[156:157], v31 offset:12288
    v_mfma_f32_32x32x16_bf16 v[64:79], v[208:211], v[240:243], v[64:79]
    ds_read_b64_tr_b16 v[158:159], v31 offset:13312
    ds_read_b128 v[184:187], v35 offset:0
    ds_read_b128 v[188:191], v35 offset:4096
    v_mfma_f32_32x32x16_bf16 v[80:95], v[212:215], v[240:243], v[80:95]
    s_add_u32 m0, s97, 49152
    s_add_u32 s18, s18, 128
    buffer_load_dwordx4 v20, s[40:43], s19 offen offset:0 lds
    v_mfma_f32_32x32x16_bf16 v[96:111], v[208:211], v[244:247], v[96:111]
    v_mfma_f32_32x32x16_bf16 v[112:127], v[212:215], v[244:247], v[112:127]
    buffer_load_dwordx4 v21, s[40:43], s19 offen offset:1024 lds
    v_mfma_f32_32x32x16_bf16 v[64:79], v[216:219], v[248:251], v[64:79]
    s_waitcnt lgkmcnt(0) vmcnt(6)
    s_mov_b64 exec, 1
    ds_add_u32 v9, v10 offset:0
    s_mov_b64 exec, -1
    v_mfma_f32_32x32x16_bf16 v[80:95], v[220:223], v[248:251], v[80:95]
    buffer_load_dwordx4 v22, s[40:43], s19 offen offset:2048 lds
    v_mfma_f32_32x32x16_bf16 v[96:111], v[216:219], v[252:255], v[96:111]
    v_mfma_f32_32x32x16_bf16 v[112:127], v[220:223], v[252:255], v[112:127]
    buffer_load_dwordx4 v23, s[40:43], s19 offen offset:3072 lds
    s_add_u32 s19, s19, 229376
    s_cmp_eq_u32 s18, s54
    s_cselect_b32 s18, s55, s18
    s_cselect_b32 s19, s96, s19
    ds_read_b32 v11, v9 offset:0
    v_mfma_f32_32x32x16_bf16 v[64:79], v[128:131], v[160:163], v[64:79]
    v_mfma_f32_32x32x16_bf16 v[80:95], v[132:135], v[160:163], v[80:95]
    s_waitcnt lgkmcnt(0)
    v_cmp_gt_u32 vcc, 16, v11
    s_cbranch_vccnz Lgs_1009
Lgb_1010:
    s_add_u32 m0, s97, 65536
    s_nop 0
    buffer_load_dwordx4 v16, s[36:39], s18 offen offset:0 lds
    ds_read_b64_tr_b16 v[192:193], v24 offset:0
    ds_read_b64_tr_b16 v[194:195], v24 offset:1024
    ds_read_b64_tr_b16 v[196:197], v25 offset:0
    v_mfma_f32_32x32x16_bf16 v[96:111], v[128:131], v[164:167], v[96:111]
    ds_read_b64_tr_b16 v[198:199], v25 offset:1024
    ds_read_b128 v[224:227], v26 offset:0
    ds_read_b128 v[228:231], v26 offset:4096
    v_mfma_f32_32x32x16_bf16 v[112:127], v[132:135], v[164:167], v[112:127]
    buffer_load_dwordx4 v17, s[36:39], s18 offen offset:1024 lds
    ds_read_b64_tr_b16 v[200:201], v24 offset:4096
    ds_read_b64_tr_b16 v[202:203], v24 offset:5120
    ds_read_b64_tr_b16 v[204:205], v25 offset:4096
    v_mfma_f32_32x32x16_bf16 v[64:79], v[136:139], v[168:171], v[64:79]
    ds_read_b64_tr_b16 v[206:207], v25 offset:5120
    ds_read_b128 v[232:235], v27 offset:0
    ds_read_b128 v[236:239], v27 offset:4096
    v_mfma_f32_32x32x16_bf16 v[80:95], v[140:143], v[168:171], v[80:95]
    buffer_load_dwordx4 v18, s[36:39], s18 offen offset:2048 lds
    ds_read_b64_tr_b16 v[208:209], v24 offset:8192
    ds_read_b64_tr_b16 v[210:211], v24 offset:9216
    ds_read_b64_tr_b16 v[212:213], v25 offset:8192
    v_mfma_f32_32x32x16_bf16 v[96:111], v[136:139], v[172:175], v[96:111]
    ds_read_b64_tr_b16 v[214:215], v25 offset:9216
    ds_read_b128 v[240:243], v28 offset:0
    ds_read_b128 v[244:247], v28 offset:4096
    v_mfma_f32_32x32x16_bf16 v[112:127], v[140:143], v[172:175], v[112:127]
    buffer_load_dwordx4 v19, s[36:39], s18 offen offset:3072 lds
    ds_read_b64_tr_b16 v[216:217], v24 offset:12288
    ds_read_b64_tr_b16 v[218:219], v24 offset:13312
    ds_read_b64_tr_b16 v[220:221], v25 offset:12288
    v_mfma_f32_32x32x16_bf16 v[64:79], v[144:147], v[176:179], v[64:79]
    ds_read_b64_tr_b16 v[222:223], v25 offset:13312
    ds_read_b128 v[248:251], v29 offset:0
    ds_read_b128 v[252:255], v29 offset:4096
    v_mfma_f32_32x32x16_bf16 v[80:95], v[148:151], v[176:179], v[80:95]
    s_add_u32 m0, s97, 81920
    s_add_u32 s18, s18, 128
    buffer_load_dwordx4 v20, s[40:43], s19 offen offset:0 lds
    v_mfma_f32_32x32x16_bf16 v[96:111], v[144:147], v[180:183], v[96:111]
    v_mfma_f32_32x32x16_bf16 v[112:127], v[148:151], v[180:183], v[112:127]
    buffer_load_dwordx4 v21, s[40:43], s19 offen offset:1024 lds
    v_mfma_f32_32x32x16_bf16 v[64:79], v[152:155], v[184:187], v[64:79]
    s_waitcnt lgkmcnt(0) vmcnt(6)
    s_mov_b64 exec, 1
    ds_add_u32 v9, v10 offset:0
    s_mov_b64 exec, -1
    v_mfma_f32_32x32x16_bf16 v[80:95], v[156:159], v[184:187], v[80:95]
    buffer_load_dwordx4 v22, s[40:43], s19 offen offset:2048 lds
    v_mfma_f32_32x32x16_bf16 v[96:111], v[152:155], v[188:191], v[96:111]
    v_mfma_f32_32x32x16_bf16 v[112:127], v[156:159], v[188:191], v[112:127]
    buffer_load_dwordx4 v23, s[40:43], s19 offen offset:3072 lds
    s_add_u32 s19, s19, 229376
    s_cmp_eq_u32 s18, s54
    s_cselect_b32 s18, s55, s18
    s_cselect_b32 s19, s96, s19
    ds_read_b32 v11, v9 offset:0
    v_mfma_f32_32x32x16_bf16 v[64:79], v[192:195], v[224:227], v[64:79]
    v_mfma_f32_32x32x16_bf16 v[80:95], v[196:199], v[224:227], v[80:95]
    s_waitcnt lgkmcnt(0)
    v_cmp_gt_u32 vcc, 20, v11
    s_cbranch_vccnz Lgs_1012
Lgb_1013:
    s_add_u32 m0, s97, 0
    s_nop 0
    buffer_load_dwordx4 v16, s[36:39], s18 offen offset:0 lds
    ds_read_b64_tr_b16 v[128:129], v24 offset:32768
    ds_read_b64_tr_b16 v[130:131], v24 offset:33792
    ds_read_b64_tr_b16 v[132:133], v25 offset:32768
    v_mfma_f32_32x32x16_bf16 v[96:111], v[192:195], v[228:231], v[96:111]
    ds_read_b64_tr_b16 v[134:135], v25 offset:33792
    ds_read_b128 v[160:163], v26 offset:32768
    ds_read_b128 v[164:167], v26 offset:36864
    v_mfma_f32_32x32x16_bf16 v[112:127], v[196:199], v[228:231], v[112:127]
    buffer_load_dwordx4 v17, s[36:39], s18 offen offset:1024 lds
    ds_read_b64_tr_b16 v[136:137], v24 offset:36864
    ds_read_b64_tr_b16 v[138:139], v24 offset:37888
    ds_read_b64_tr_b16 v[140:141], v25 offset:36864
    v_mfma_f32_32x32x16_bf16 v[64:79], v[200:203], v[232:235], v[64:79]
    ds_read_b64_tr_b16 v[142:143], v25 offset:37888
    ds_read_b128 v[168:171], v27 offset:32768
    ds_read_b128 v[172:175], v27 offset:36864
    v_mfma_f32_32x32x16_bf16 v[80:95], v[204:207], v[232:235], v[80:95]
    buffer_load_dwordx4 v18, s[36:39], s18 offen offset:2048 lds
    ds_read_b64_tr_b16 v[144:145], v24 offset:40960
    ds_read_b64_tr_b16 v[146:147], v24 offset:41984
    ds_read_b64_tr_b16 v[148:149], v25 offset:40960
    v_mfma_f32_32x32x16_bf16 v[96:111], v[200:203], v[236:239], v[96:111]
    ds_read_b64_tr_b16 v[150:151], v25 offset:41984
    ds_read_b128 v[176:179], v28 offset:32768
    ds_read_b128 v[180:183], v28 offset:36864
    v_mfma_f32_32x32x16_bf16 v[112:127], v[204:207], v[236:239], v[112:127]
    buffer_load_dwordx4 v19, s[36:39], s18 offen offset:3072 lds
    ds_read_b64_tr_b16 v[152:153], v24 offset:45056
    ds_read_b64_tr_b16 v[154:155], v24 offset:46080
    ds_read_b64_tr_b16 v[156:157], v25 offset:45056
    v_mfma_f32_32x32x16_bf16 v[64:79], v[208:211], v[240:243], v[64:79]
    ds_read_b64_tr_b16 v[158:159], v25 offset:46080
    ds_read_b128 v[184:187], v29 offset:32768
    ds_read_b128 v[188:191], v29 offset:36864
    v_mfma_f32_32x32x16_bf16 v[80:95], v[212:215], v[240:243], v[80:95]
    s_add_u32 m0, s97, 16384
    s_add_u32 s18, s18, 128
    buffer_load_dwordx4 v20, s[40:43], s19 offen offset:0 lds
    v_mfma_f32_32x32x16_bf16 v[96:111], v[208:211], v[244:247], v[96:111]
    v_mfma_f32_32x32x16_bf16 v[112:127], v[212:215], v[244:247], v[112:127]
    buffer_load_dwordx4 v21, s[40:43], s19 offen offset:1024 lds
    v_mfma_f32_32x32x16_bf16 v[64:79], v[216:219], v[248:251], v[64:79]
    s_waitcnt lgkmcnt(0) vmcnt(6)
    s_mov_b64 exec, 1
    ds_add_u32 v9, v10 offset:0
    s_mov_b64 exec, -1
    v_mfma_f32_32x32x16_bf16 v[80:95], v[220:223], v[248:251], v[80:95]
    buffer_load_dwordx4 v22, s[40:43], s19 offen offset:2048 lds
    v_mfma_f32_32x32x16_bf16 v[96:111], v[216:219], v[252:255], v[96:111]
    v_mfma_f32_32x32x16_bf16 v[112:127], v[220:223], v[252:255], v[112:127]
    buffer_load_dwordx4 v23, s[40:43], s19 offen offset:3072 lds
    s_add_u32 s19, s19, 229376
    s_cmp_eq_u32 s18, s54
    s_cselect_b32 s18, s55, s18
    s_cselect_b32 s19, s96, s19
    ds_read_b32 v11, v9 offset:0
    v_mfma_f32_32x32x16_bf16 v[64:79], v[128:131], v[160:163], v[64:79]
    v_mfma_f32_32x32x16_bf16 v[80:95], v[132:135], v[160:163], v[80:95]
    s_waitcnt lgkmcnt(0)
    v_cmp_gt_u32 vcc, 24, v11
    s_cbranch_vccnz Lgs_1015
Lgb_1016:
    s_add_u32 m0, s97, 32768
    s_nop 0
    buffer_load_dwordx4 v16, s[36:39], s18 offen offset:0 lds
    ds_read_b64_tr_b16 v[192:193], v30 offset:0
    ds_read_b64_tr_b16 v[194:195], v30 offset:1024
    ds_read_b64_tr_b16 v[196:197], v31 offset:0
    v_mfma_f32_32x32x16_bf16 v[96:111], v[128:131], v[164:167], v[96:111]
    ds_read_b64_tr_b16 v[198:199], v31 offset:1024
    ds_read_b128 v[224:227], v32 offset:0
    ds_read_b128 v[228:231], v32 offset:4096
    v_mfma_f32_32x32x16_bf16 v[112:127], v[132:135], v[164:167], v[112:127]
    buffer_load_dwordx4 v17, s[36:39], s18 offen offset:1024 lds
    ds_read_b64_tr_b16 v[200:201], v30 offset:4096
    ds_read_b64_tr_b16 v[202:203], v30 offset:5120
    ds_read_b64_tr_b16 v[204:205], v31 offset:4096
    v_mfma_f32_32x32x16_bf16 v[64:79], v[136:139], v[168:171], v[64:79]
    ds_read_b64_tr_b16 v[206:207], v31 offset:5120
    ds_read_b128 v[232:235], v33 offset:0
    ds_read_b128 v[236:239], v33 offset:4096
    v_mfma_f32_32x32x16_bf16 v[80:95], v[140:143], v[168:171], v[80:95]
    buffer_load_dwordx4 v18, s[36:39], s18 offen offset:2048 lds
    ds_read_b64_tr_b16 v[208:209], v30 offset:8192
    ds_read_b64_tr_b16 v[210:211], v30 offset:9216
    ds_read_b64_tr_b16 v[212:213], v31 offset:8192
    v_mfma_f32_32x32x16_bf16 v[96:111], v[136:139], v[172:175], v[96:111]
    ds_read_b64_tr_b16 v[214:215], v31 offset:9216
    ds_read_b128 v[240:243], v34 offset:0
    ds_read_b128 v[244:247], v34 offset:4096
    v_mfma_f32_32x32x16_bf16 v[112:127], v[140:143], v[172:175], v[112:127]
    buffer_load_dwordx4 v19, s[36:39], s18 offen offset:3072 lds
    ds_read_b64_tr_b16 v[216:217], v30 offset:12288
    ds_read_b64_tr_b16 v[218:219], v30 offset:13312
    ds_read_b64_tr_b16 v[220:221], v31 offset:12288
    v_mfma_f32_32x32x16_bf16 v[64:79], v[144:147], v[176:179], v[64:79]
    ds_read_b64_tr_b16 v[222:223], v31 offset:13312
    ds_read_b128 v[248:251], v35 offset:0
    ds_read_b128 v[252:255], v35 offset:4096
    v_mfma_f32_32x32x16_bf16 v[80:95], v[148:151], v[176:179], v[80:95]
    s_add_u32 m0, s97, 49152
    s_add_u32 s18, s18, 128
    buffer_load_dwordx4 v20, s[40:43], s19 offen offset:0 lds
    v_mfma_f32_32x32x16_bf16 v[96:111], v[144:147], v[180:183], v[96:111]
    v_mfma_f32_32x32x16_bf16 v[112:127], v[148:151], v[180:183], v[112:127]
    buffer_load_dwordx4 v21, s[40:43], s19 offen offset:1024 lds
    v_mfma_f32_32x32x16_bf16 v[64:79], v[152:155], v[184:187], v[64:79]
    s_waitcnt lgkmcnt(0) vmcnt(6)
    s_mov_b64 exec, 1
    ds_add_u32 v9, v10 offset:0
    s_mov_b64 exec, -1
    v_mfma_f32_32x32x16_bf16 v[80:95], v[156:159], v[184:187], v[80:95]
    buffer_load_dwordx4 v22, s[40:43], s19 offen offset:2048 lds
    v_mfma_f32_32x32x16_bf16 v[96:111], v[152:155], v[188:191], v[96:111]
    v_mfma_f32_32x32x16_bf16 v[112:127], v[156:159], v[188:191], v[112:127]
    buffer_load_dwordx4 v23, s[40:43], s19 offen offset:3072 lds
    ds_read_b32 v11, v9 offset:0
    v_mfma_f32_32x32x16_bf16 v[64:79], v[192:195], v[224:227], v[64:79]
    buffer_load_dwordx4 v[36:39], v1, s[44:47], s93 offen sc1
    buffer_load_dwordx4 v[40:43], v60, s[44:47], s92 offen sc1
    buffer_load_dwordx4 v[44:47], v60, s[44:47], s92 offen offset:512 sc1
    v_mfma_f32_32x32x16_bf16 v[80:95], v[196:199], v[224:227], v[80:95]
    s_waitcnt lgkmcnt(0)
    v_cmp_gt_u32 vcc, 28, v11
    s_cbranch_vccnz Lgs_1018
Lgb_1019:
    s_add_u32 m0, s98, 65536
    s_add_u32 s34, s11, 0
    buffer_load_dwordx4 v3, s[48:51], s34 offen lds
    ds_read_b64_tr_b16 v[128:129], v24 offset:0
    ds_read_b64_tr_b16 v[130:131], v24 offset:1024
    ds_read_b64_tr_b16 v[132:133], v25 offset:0
    v_mfma_f32_32x32x16_bf16 v[96:111], v[192:195], v[228:231], v[96:111]
    ds_read_b64_tr_b16 v[134:135], v25 offset:1024
    ds_read_b128 v[160:163], v26 offset:0
    ds_read_b128 v[164:167], v26 offset:4096
    v_mfma_f32_32x32x16_bf16 v[112:127], v[196:199], v[228:231], v[112:127]
    buffer_load_dwordx4 v4, s[48:51], s34 offen offset:1024 lds
    ds_read_b64_tr_b16 v[136:137], v24 offset:4096
    ds_read_b64_tr_b16 v[138:139], v24 offset:5120
    ds_read_b64_tr_b16 v[140:141], v25 offset:4096
    v_mfma_f32_32x32x16_bf16 v[64:79], v[200:203], v[232:235], v[64:79]
    ds_read_b64_tr_b16 v[142:143], v25 offset:5120
    ds_read_b128 v[168:171], v27 offset:0
    ds_read_b128 v[172:175], v27 offset:4096
    v_mfma_f32_32x32x16_bf16 v[80:95], v[204:207], v[232:235], v[80:95]
    s_add_u32 m0, s98, 67584
    s_add_u32 s34, s12, 0
    buffer_load_dwordx4 v3, s[48:51], s34 offen lds
    ds_read_b64_tr_b16 v[144:145], v24 offset:8192
    ds_read_b64_tr_b16 v[146:147], v24 offset:9216
    ds_read_b64_tr_b16 v[148:149], v25 offset:8192
    v_mfma_f32_32x32x16_bf16 v[96:111], v[200:203], v[236:239], v[96:111]
    ds_read_b64_tr_b16 v[150:151], v25 offset:9216
    ds_read_b128 v[176:179], v28 offset:0
    ds_read_b128 v[180:183], v28 offset:4096
    v_mfma_f32_32x32x16_bf16 v[112:127], v[204:207], v[236:239], v[112:127]
    buffer_load_dwordx4 v4, s[48:51], s34 offen offset:1024 lds
    ds_read_b64_tr_b16 v[152:153], v24 offset:12288
    ds_read_b64_tr_b16 v[154:155], v24 offset:13312
    ds_read_b64_tr_b16 v[156:157], v25 offset:12288
    v_mfma_f32_32x32x16_bf16 v[64:79], v[208:211], v[240:243], v[64:79]
    ds_read_b64_tr_b16 v[158:159], v25 offset:13312
    ds_read_b128 v[184:187], v29 offset:0
    ds_read_b128 v[188:191], v29 offset:4096
    v_mfma_f32_32x32x16_bf16 v[80:95], v[212:215], v[240:243], v[80:95]
    s_add_u32 m0, s98, 69632
    s_add_u32 s34, s13, 0
    buffer_load_dwordx4 v3, s[48:51], s34 offen lds
    v_mfma_f32_32x32x16_bf16 v[96:111], v[208:211], v[244:247], v[96:111]
    v_mfma_f32_32x32x16_bf16 v[112:127], v[212:215], v[244:247], v[112:127]
    buffer_load_dwordx4 v4, s[48:51], s34 offen offset:1024 lds
    v_mfma_f32_32x32x16_bf16 v[64:79], v[216:219], v[248:251], v[64:79]
    s_waitcnt lgkmcnt(0) vmcnt(9)
    s_mov_b64 exec, 1
    ds_add_u32 v9, v10 offset:0
    s_mov_b64 exec, -1
    v_mfma_f32_32x32x16_bf16 v[80:95], v[220:223], v[248:251], v[80:95]
    s_add_u32 m0, s98, 71680
    s_add_u32 s34, s14, 0
    buffer_load_dwordx4 v3, s[48:51], s34 offen lds
    v_mfma_f32_32x32x16_bf16 v[96:111], v[216:219], v[252:255], v[96:111]
    v_mfma_f32_32x32x16_bf16 v[112:127], v[220:223], v[252:255], v[112:127]
    buffer_load_dwordx4 v4, s[48:51], s34 offen offset:1024 lds
    ds_read_b32 v11, v9 offset:0
    v_mfma_f32_32x32x16_bf16 v[64:79], v[128:131], v[160:163], v[64:79]
    v_mfma_f32_32x32x16_bf16 v[80:95], v[132:135], v[160:163], v[80:95]
    s_waitcnt lgkmcnt(0)
    v_cmp_gt_u32 vcc, 32, v11
    s_cbranch_vccnz Lgs_1021
Lgb_1022:
    s_add_u32 m0, s98, 0
    s_add_u32 s34, s15, 0
    buffer_load_dwordx4 v3, s[48:51], s34 offen lds
    ds_read_b64_tr_b16 v[192:193], v24 offset:32768
    ds_read_b64_tr_b16 v[194:195], v24 offset:33792
    ds_read_b64_tr_b16 v[196:197], v25 offset:32768
    v_mfma_f32_32x32x16_bf16 v[96:111], v[128:131], v[164:167], v[96:111]
    ds_read_b64_tr_b16 v[198:199], v25 offset:33792
    ds_read_b128 v[224:227], v26 offset:32768
    ds_read_b128 v[228:231], v26 offset:36864
    v_mfma_f32_32x32x16_bf16 v[112:127], v[132:135], v[164:167], v[112:127]
    buffer_load_dwordx4 v4, s[48:51], s34 offen offset:1024 lds
    ds_read_b64_tr_b16 v[200:201], v24 offset:36864
    ds_read_b64_tr_b16 v[202:203], v24 offset:37888
    ds_read_b64_tr_b16 v[204:205], v25 offset:36864
    v_mfma_f32_32x32x16_bf16 v[64:79], v[136:139], v[168:171], v[64:79]
    ds_read_b64_tr_b16 v[206:207], v25 offset:37888
    ds_read_b128 v[232:235], v27 offset:32768
    ds_read_b128 v[236:239], v27 offset:36864
    v_mfma_f32_32x32x16_bf16 v[80:95], v[140:143], v[168:171], v[80:95]
    s_add_u32 m0, s98, 2048
    s_add_u32 s34, s16, 0
    buffer_load_dwordx4 v3, s[48:51], s34 offen lds
    ds_read_b64_tr_b16 v[208:209], v24 offset:40960
    ds_read_b64_tr_b16 v[210:211], v24 offset:41984
    ds_read_b64_tr_b16 v[212:213], v25 offset:40960
    v_mfma_f32_32x32x16_bf16 v[96:111], v[136:139], v[172:175], v[96:111]
    ds_read_b64_tr_b16 v[214:215], v25 offset:41984
    ds_read_b128 v[240:243], v28 offset:32768
    ds_read_b128 v[244:247], v28 offset:36864
    v_mfma_f32_32x32x16_bf16 v[112:127], v[140:143], v[172:175], v[112:127]
    buffer_load_dwordx4 v4, s[48:51], s34 offen offset:1024 lds
    ds_read_b64_tr_b16 v[216:217], v24 offset:45056
    ds_read_b64_tr_b16 v[218:219], v24 offset:46080
    ds_read_b64_tr_b16 v[220:221], v25 offset:45056
    v_mfma_f32_32x32x16_bf16 v[64:79], v[144:147], v[176:179], v[64:79]
    ds_read_b64_tr_b16 v[222:223], v25 offset:46080
    ds_read_b128 v[248:251], v29 offset:32768
    ds_read_b128 v[252:255], v29 offset:36864
    v_mfma_f32_32x32x16_bf16 v[80:95], v[148:151], v[176:179], v[80:95]
    s_add_u32 m0, s98, 4096
    s_add_u32 s34, s17, 0
    buffer_load_dwordx4 v3, s[48:51], s34 offen lds
    v_mfma_f32_32x32x16_bf16 v[96:111], v[144:147], v[180:183], v[96:111]
    v_mfma_f32_32x32x16_bf16 v[112:127], v[148:151], v[180:183], v[112:127]
    buffer_load_dwordx4 v4, s[48:51], s34 offen offset:1024 lds
    v_mfma_f32_32x32x16_bf16 v[64:79], v[152:155], v[184:187], v[64:79]
    s_waitcnt lgkmcnt(0)
    s_mov_b64 exec, 1
    ds_add_u32 v9, v10 offset:0
    s_mov_b64 exec, -1
    v_mfma_f32_32x32x16_bf16 v[80:95], v[156:159], v[184:187], v[80:95]
    s_add_u32 m0, s98, 6144
    s_add_u32 s34, s11, 16384
    buffer_load_dwordx4 v3, s[48:51], s34 offen lds
    v_mfma_f32_32x32x16_bf16 v[96:111], v[152:155], v[188:191], v[96:111]
    v_mfma_f32_32x32x16_bf16 v[112:127], v[156:159], v[188:191], v[112:127]
    buffer_load_dwordx4 v4, s[48:51], s34 offen offset:1024 lds
    ds_read_b32 v11, v9 offset:0
    v_mfma_f32_32x32x16_bf16 v[64:79], v[192:195], v[224:227], v[64:79]
    v_mfma_f32_32x32x16_bf16 v[96:111], v[192:195], v[228:231], v[96:111]
    s_waitcnt lgkmcnt(0)
    v_cmp_gt_u32 vcc, 36, v11
    s_cbranch_vccnz Lgs_1027
Lgb_1028:
    s_add_u32 m0, s98, 32768
    s_add_u32 s34, s12, 16384
    buffer_load_dwordx4 v3, s[48:51], s34 offen lds
    v_mfma_f32_32x32x16_bf16 v[64:79], v[200:203], v[232:235], v[64:79]
    v_mfma_f32_32x32x16_bf16 v[96:111], v[200:203], v[236:239], v[96:111]
    buffer_load_dwordx4 v4, s[48:51], s34 offen offset:1024 lds
    v_mfma_f32_32x32x16_bf16 v[64:79], v[208:211], v[240:243], v[64:79]
    v_mfma_f32_32x32x16_bf16 v[96:111], v[208:211], v[244:247], v[96:111]
    s_waitcnt vmcnt(18)
    v_cmp_ne_u32 vcc, s35, v39
    v_cmp_ne_u32 s[60:61], s35, v43
    s_or_b64 vcc, vcc, s[60:61]
    v_cmp_ne_u32 s[60:61], s35, v47
    s_or_b64 vcc, vcc, s[60:61]
    s_cbranch_vccnz Lgr_1024
Lgrb_1025:
    s_add_u32 m0, s98, 34816
    s_add_u32 s34, s13, 16384
    buffer_load_dwordx4 v3, s[48:51], s34 offen lds
    v_mfma_f32_32x32x16_bf16 v[64:79], v[216:219], v[248:251], v[64:79]
    v_mov_b32 v39, 0
    v_mov_b32 v43, 0
    v_mov_b32 v47, 0
    v_mov_b32 v51, 0
    v_cmp_gt_u32 vcc, 32, v0
    v_mfma_f32_32x32x16_bf16 v[96:111], v[216:219], v[252:255], v[96:111]
    s_nop 0
    v_cndmask_b32 v48, v36, v51, vcc
    v_cndmask_b32 v49, v37, v51, vcc
    v_cndmask_b32 v50, v38, v51, vcc
    v_cndmask_b32 v36, v51, v36, vcc
    v_cndmask_b32 v37, v51, v37, vcc
    v_cndmask_b32 v38, v51, v38, vcc
    buffer_load_dwordx4 v4, s[48:51], s34 offen offset:1024 lds
    s_nop 0
    v_mfma_f32_32x32x16_bf16 v[64:79], v[36:39], v[40:43], v[64:79]
    v_and_b32 v54, 0xffff0000, v41
    v_lshlrev_b32 v55, 16, v42
    v_add_f32 v54, v54, v55
    v_and_b32 v58, 0xffff0000, v45
    v_lshlrev_b32 v59, 16, v46
    v_add_f32 v58, v58, v59
    v_mfma_f32_32x32x16_bf16 v[96:111], v[36:39], v[44:47], v[96:111]
    v_rcp_f32 v55, v54
    v_rcp_f32 v59, v58
    v_mul_f32 v53, 0xc0135761, v55
    v_mul_f32 v52, v55, v55
    v_mul_f32 v57, 0xc0135761, v59
    v_mul_f32 v56, v59, v59
    v_mfma_f32_32x32x16_bf16 v[80:95], v[196:199], v[224:227], v[80:95]
    v_mul_f32 v52, v52, v53
    v_mul_f32 v52, 0x3d372713, v52
    v_mul_f32 v56, v56, v57
    v_mul_f32 v56, 0x3d372713, v56
    v_mul_f32 v16, v64, v64
    v_mul_f32 v17, v65, v65
    v_mul_f32 v18, v66, v66
    v_mul_f32 v19, v67, v67
    v_mul_f32 v20, v68, v68
    s_add_u32 m0, s98, 36864
    s_add_u32 s34, s14, 16384
    buffer_load_dwordx4 v3, s[48:51], s34 offen lds
    v_mul_f32 v21, v69, v69
    v_mfma_f32_32x32x16_bf16 v[112:127], v[196:199], v[228:231], v[112:127]
    v_mul_f32 v22, v70, v70
    v_mul_f32 v23, v71, v71
    v_mul_f32 v24, v96, v96
    v_mul_f32 v25, v97, v97
    v_mul_f32 v26, v98, v98
    v_mul_f32 v27, v99, v99
    v_mfma_f32_32x32x16_bf16 v[80:95], v[204:207], v[232:235], v[80:95]
    v_mul_f32 v28, v100, v100
    v_mul_f32 v29, v101, v101
    v_mul_f32 v30, v102, v102
    v_mul_f32 v31, v103, v103
    buffer_load_dwordx4 v4, s[48:51], s34 offen offset:1024 lds
    v_fma_f32 v16, v16, v52, v53
    v_fma_f32 v17, v17, v52, v53
    v_mfma_f32_32x32x16_bf16 v[112:127], v[204:207], v[236:239], v[112:127]
    v_fma_f32 v18, v18, v52, v53
    v_fma_f32 v19, v19, v52, v53
    v_fma_f32 v20, v20, v52, v53
    v_fma_f32 v21, v21, v52, v53
    v_fma_f32 v22, v22, v52, v53
    v_fma_f32 v23, v23, v52, v53
    v_mfma_f32_32x32x16_bf16 v[80:95], v[212:215], v[240:243], v[80:95]
    v_fma_f32 v24, v24, v56, v57
    v_fma_f32 v25, v25, v56, v57
    s_add_u32 m0, s98, 38912
    s_add_u32 s34, s15, 16384
    buffer_load_dwordx4 v3, s[48:51], s34 offen lds
    v_fma_f32 v26, v26, v56, v57
    v_fma_f32 v27, v27, v56, v57
    v_fma_f32 v28, v28, v56, v57
    v_fma_f32 v29, v29, v56, v57
    v_mfma_f32_32x32x16_bf16 v[112:127], v[212:215], v[244:247], v[112:127]
    v_fma_f32 v30, v30, v56, v57
    v_fma_f32 v31, v31, v56, v57
    v_mul_f32 v16, v16, v64
    v_mul_f32 v17, v17, v65
    v_mul_f32 v18, v18, v66
    v_mul_f32 v19, v19, v67
    v_mfma_f32_32x32x16_bf16 v[80:95], v[220:223], v[248:251], v[80:95]
    v_mul_f32 v20, v20, v68
    buffer_load_dwordx4 v4, s[48:51], s34 offen offset:1024 lds
    v_mul_f32 v21, v21, v69
    v_mul_f32 v22, v22, v70
    v_mul_f32 v23, v23, v71
    v_mul_f32 v24, v24, v96
    v_mul_f32 v25, v25, v97
    v_mfma_f32_32x32x16_bf16 v[112:127], v[220:223], v[252:255], v[112:127]
    v_mul_f32 v26, v26, v98
    v_mul_f32 v27, v27, v99
    v_mul_f32 v28, v28, v100
    v_mul_f32 v29, v29, v101
    v_mul_f32 v30, v30, v102
    v_mul_f32 v31, v31, v103
    v_mfma_f32_32x32x16_bf16 v[80:95], v[48:51], v[40:43], v[80:95]
    v_exp_f32 v16, v16
    v_exp_f32 v17, v17
    v_exp_f32 v18, v18
    v_exp_f32 v19, v19
    v_exp_f32 v20, v20
    v_exp_f32 v21, v21
    v_mfma_f32_32x32x16_bf16 v[112:127], v[48:51], v[44:47], v[112:127]
    v_exp_f32 v22, v22
    v_exp_f32 v23, v23
    v_exp_f32 v24, v24
    v_exp_f32 v25, v25
    v_exp_f32 v26, v26
    v_exp_f32 v27, v27
    v_exp_f32 v28, v28
    v_exp_f32 v29, v29
    v_exp_f32 v30, v30
    v_exp_f32 v31, v31
    v_fma_f32 v16, v16, v54, v54
    v_fma_f32 v17, v17, v54, v54
    v_fma_f32 v18, v18, v54, v54
    v_fma_f32 v19, v19, v54, v54
    v_fma_f32 v20, v20, v54, v54
    v_fma_f32 v21, v21, v54, v54
    v_fma_f32 v22, v22, v54, v54
    v_fma_f32 v23, v23, v54, v54
    v_fma_f32 v24, v24, v58, v58
    v_fma_f32 v25, v25, v58, v58
    v_fma_f32 v26, v26, v58, v58
    v_fma_f32 v27, v27, v58, v58
    v_fma_f32 v28, v28, v58, v58
    v_fma_f32 v29, v29, v58, v58
    v_fma_f32 v30, v30, v58, v58
    v_fma_f32 v31, v31, v58, v58
    v_rcp_f32 v16, v16
    v_rcp_f32 v17, v17
    v_rcp_f32 v18, v18
    v_rcp_f32 v19, v19
    v_rcp_f32 v20, v20
    v_rcp_f32 v21, v21
    v_rcp_f32 v22, v22
    v_rcp_f32 v23, v23
    v_rcp_f32 v24, v24
    v_rcp_f32 v25, v25
    v_rcp_f32 v26, v26
    v_rcp_f32 v27, v27
    v_rcp_f32 v28, v28
    v_rcp_f32 v29, v29
    v_rcp_f32 v30, v30
    v_rcp_f32 v31, v31
    v_mul_f32 v16, v16, v64
    v_mul_f32 v17, v17, v65
    v_mul_f32 v18, v18, v66
    v_mul_f32 v19, v19, v67
    v_mul_f32 v20, v20, v68
    v_mul_f32 v21, v21, v69
    v_mul_f32 v22, v22, v70
    v_mul_f32 v23, v23, v71
    v_mul_f32 v24, v24, v96
    v_mul_f32 v25, v25, v97
    v_mul_f32 v26, v26, v98
    v_mul_f32 v27, v27, v99
    v_mul_f32 v28, v28, v100
    v_mul_f32 v29, v29, v101
    v_mul_f32 v30, v30, v102
    v_mul_f32 v31, v31, v103
    v_cvt_pk_bf16_f32 v32, v16, v17
    v_cvt_pk_bf16_f32 v33, v18, v19
    v_cvt_pk_bf16_f32 v34, v20, v21
    v_cvt_pk_bf16_f32 v35, v22, v23
    v_cvt_pk_bf16_f32 v60, v24, v25
    v_cvt_pk_bf16_f32 v61, v26, v27
    v_cvt_pk_bf16_f32 v62, v28, v29
    v_cvt_pk_bf16_f32 v63, v30, v31
    buffer_store_dwordx4 v[32:35], v1, s[44:47], s99 offen sc1
    buffer_store_dwordx4 v[60:63], v2, s[44:47], s99 offen sc1
    s_add_u32 s99, s99, 28672
    v_mul_f32 v16, v72, v72
    v_mul_f32 v17, v73, v73
    v_mul_f32 v18, v74, v74
    v_mul_f32 v19, v75, v75
    v_mul_f32 v20, v76, v76
    v_mul_f32 v21, v77, v77
    v_mul_f32 v22, v78, v78
    v_mul_f32 v23, v79, v79
    v_mul_f32 v24, v104, v104
    v_mul_f32 v25, v105, v105
    v_mul_f32 v26, v106, v106
    v_mul_f32 v27, v107, v107
    v_mul_f32 v28, v108, v108
    v_mul_f32 v29, v109, v109
    v_mul_f32 v30, v110, v110
    s_waitcnt vmcnt(24)
    ds_read_b64_tr_b16 v[128:129], v7 offset:0
    ds_read_b64_tr_b16 v[130:131], v7 offset:1024
    ds_read_b64_tr_b16 v[132:133], v8 offset:0
    ds_read_b64_tr_b16 v[134:135], v8 offset:1024
    v_mul_f32 v31, v111, v111
    v_fma_f32 v16, v16, v52, v53
    v_fma_f32 v17, v17, v52, v53
    v_fma_f32 v18, v18, v52, v53
    v_fma_f32 v19, v19, v52, v53
    v_fma_f32 v20, v20, v52, v53
    v_fma_f32 v21, v21, v52, v53
    v_fma_f32 v22, v22, v52, v53
    v_fma_f32 v23, v23, v52, v53
    v_fma_f32 v24, v24, v56, v57
    v_fma_f32 v25, v25, v56, v57
    v_fma_f32 v26, v26, v56, v57
    v_fma_f32 v27, v27, v56, v57
    v_fma_f32 v28, v28, v56, v57
    v_fma_f32 v29, v29, v56, v57
    v_fma_f32 v30, v30, v56, v57
    v_fma_f32 v31, v31, v56, v57
    v_mul_f32 v16, v16, v72
    v_mul_f32 v17, v17, v73
    v_mul_f32 v18, v18, v74
    v_mul_f32 v19, v19, v75
    v_mul_f32 v20, v20, v76
    s_waitcnt vmcnt(22)
    ds_read_b64_tr_b16 v[136:137], v7 offset:2048
    ds_read_b64_tr_b16 v[138:139], v7 offset:3072
    ds_read_b64_tr_b16 v[140:141], v8 offset:2048
    ds_read_b64_tr_b16 v[142:143], v8 offset:3072
    v_mul_f32 v21, v21, v77
    v_mul_f32 v22, v22, v78
    v_mul_f32 v23, v23, v79
    v_mul_f32 v24, v24, v104
    v_mul_f32 v25, v25, v105
    v_mul_f32 v26, v26, v106
    v_mul_f32 v27, v27, v107
    v_mul_f32 v28, v28, v108
    v_mul_f32 v29, v29, v109
    v_mul_f32 v30, v30, v110
    v_mul_f32 v31, v31, v111
    v_exp_f32 v16, v16
    v_exp_f32 v17, v17
    v_exp_f32 v18, v18
    v_exp_f32 v19, v19
    v_exp_f32 v20, v20
    v_exp_f32 v21, v21
    s_waitcnt vmcnt(20)
    ds_read_b64_tr_b16 v[144:145], v7 offset:4096
    ds_read_b64_tr_b16 v[146:147], v7 offset:5120
    ds_read_b64_tr_b16 v[148:149], v8 offset:4096
    ds_read_b64_tr_b16 v[150:151], v8 offset:5120
    v_exp_f32 v22, v22
    v_exp_f32 v23, v23
    v_exp_f32 v24, v24
    v_exp_f32 v25, v25
    v_exp_f32 v26, v26
    v_exp_f32 v27, v27
    v_exp_f32 v28, v28
    v_exp_f32 v29, v29
    v_exp_f32 v30, v30
    v_exp_f32 v31, v31
    v_fma_f32 v16, v16, v54, v54
    s_waitcnt vmcnt(18)
    ds_read_b64_tr_b16 v[152:153], v7 offset:6144
    ds_read_b64_tr_b16 v[154:155], v7 offset:7168
    ds_read_b64_tr_b16 v[156:157], v8 offset:6144
    ds_read_b64_tr_b16 v[158:159], v8 offset:7168
    v_fma_f32 v17, v17, v54, v54
    v_fma_f32 v18, v18, v54, v54
    v_fma_f32 v19, v19, v54, v54
    v_fma_f32 v20, v20, v54, v54
    v_fma_f32 v21, v21, v54, v54
    v_fma_f32 v22, v22, v54, v54
    v_fma_f32 v23, v23, v54, v54
    v_fma_f32 v24, v24, v58, v58
    v_fma_f32 v25, v25, v58, v58
    v_fma_f32 v26, v26, v58, v58
    v_fma_f32 v27, v27, v58, v58
    v_fma_f32 v28, v28, v58, v58
    v_fma_f32 v29, v29, v58, v58
    v_fma_f32 v30, v30, v58, v58
    v_fma_f32 v31, v31, v58, v58
    v_rcp_f32 v16, v16
    v_rcp_f32 v17, v17
    v_rcp_f32 v18, v18
    s_waitcnt vmcnt(16)
    ds_read_b64_tr_b16 v[160:161], v5 offset:0
    ds_read_b64_tr_b16 v[162:163], v5 offset:1024
    ds_read_b64_tr_b16 v[164:165], v6 offset:0
    ds_read_b64_tr_b16 v[166:167], v6 offset:1024
    s_waitcnt vmcnt(0)
    buffer_store_dword v12, off, s[44:47], s100 offset:0 sc1
    v_rcp_f32 v19, v19
    v_rcp_f32 v20, v20
    v_rcp_f32 v21, v21
    v_rcp_f32 v22, v22
    v_rcp_f32 v23, v23
    v_rcp_f32 v24, v24
    v_rcp_f32 v25, v25
    v_rcp_f32 v26, v26
    v_rcp_f32 v27, v27
    v_rcp_f32 v28, v28
    v_rcp_f32 v29, v29
    s_waitcnt vmcnt(15)
    ds_read_b64_tr_b16 v[168:169], v5 offset:2048
    ds_read_b64_tr_b16 v[170:171], v5 offset:3072
    ds_read_b64_tr_b16 v[172:173], v6 offset:2048
    ds_read_b64_tr_b16 v[174:175], v6 offset:3072
    v_rcp_f32 v30, v30
    v_rcp_f32 v31, v31
    v_mul_f32 v16, v16, v72
    v_mul_f32 v17, v17, v73
    v_mul_f32 v18, v18, v74
    v_mul_f32 v19, v19, v75
    v_mul_f32 v20, v20, v76
    v_mul_f32 v21, v21, v77
    v_mul_f32 v22, v22, v78
    v_mul_f32 v23, v23, v79
    v_mul_f32 v24, v24, v104
    v_mul_f32 v25, v25, v105
    v_mul_f32 v26, v26, v106
    v_mul_f32 v27, v27, v107
    v_mul_f32 v28, v28, v108
    v_mul_f32 v29, v29, v109
    v_mul_f32 v30, v30, v110
    v_mul_f32 v31, v31, v111
    v_cvt_pk_bf16_f32 v32, v16, v17
    v_cvt_pk_bf16_f32 v33, v18, v19
    s_waitcnt vmcnt(13)
    ds_read_b64_tr_b16 v[176:177], v5 offset:4096
    ds_read_b64_tr_b16 v[178:179], v5 offset:5120
    ds_read_b64_tr_b16 v[180:181], v6 offset:4096
    ds_read_b64_tr_b16 v[182:183], v6 offset:5120
    v_cvt_pk_bf16_f32 v34, v20, v21
    v_cvt_pk_bf16_f32 v35, v22, v23
    v_cvt_pk_bf16_f32 v60, v24, v25
    v_cvt_pk_bf16_f32 v61, v26, v27
    v_cvt_pk_bf16_f32 v62, v28, v29
    v_cvt_pk_bf16_f32 v63, v30, v31
    buffer_store_dwordx4 v[32:35], v1, s[44:47], s99 offen sc1
    buffer_store_dwordx4 v[60:63], v2, s[44:47], s99 offen sc1
    s_add_u32 s99, s99, 28672
    v_mul_f32 v16, v80, v80
    v_mul_f32 v17, v81, v81
    v_mul_f32 v18, v82, v82
    v_mul_f32 v19, v83, v83
    v_mul_f32 v20, v84, v84
    v_mul_f32 v21, v85, v85
    v_mul_f32 v22, v86, v86
    v_mul_f32 v23, v87, v87
    v_mul_f32 v24, v112, v112
    v_mul_f32 v25, v113, v113
    v_mul_f32 v26, v114, v114
    s_waitcnt lgkmcnt(0)
    s_add_u32 m0, s98, 65536
    s_add_u32 s34, s16, 16384
    buffer_load_dwordx4 v3, s[48:51], s34 offen lds
    v_mul_f32 v27, v115, v115
    v_mul_f32 v28, v116, v116
    v_mul_f32 v29, v117, v117
    s_waitcnt vmcnt(14)
    ds_read_b64_tr_b16 v[184:185], v5 offset:6144
    ds_read_b64_tr_b16 v[186:187], v5 offset:7168
    ds_read_b64_tr_b16 v[188:189], v6 offset:6144
    ds_read_b64_tr_b16 v[190:191], v6 offset:7168
    v_mul_f32 v30, v118, v118
    v_mul_f32 v31, v119, v119
    v_fma_f32 v16, v16, v52, v53
    v_fma_f32 v17, v17, v52, v53
    v_fma_f32 v18, v18, v52, v53
    v_fma_f32 v19, v19, v52, v53
    v_fma_f32 v20, v20, v52, v53
    v_fma_f32 v21, v21, v52, v53
    v_fma_f32 v22, v22, v52, v53
    v_fma_f32 v23, v23, v52, v53
    v_fma_f32 v24, v24, v56, v57
    v_fma_f32 v25, v25, v56, v57
    v_fma_f32 v26, v26, v56, v57
    v_fma_f32 v27, v27, v56, v57
    v_fma_f32 v28, v28, v56, v57
    v_fma_f32 v29, v29, v56, v57
    v_fma_f32 v30, v30, v56, v57
    v_fma_f32 v31, v31, v56, v57
    v_mul_f32 v16, v16, v80
    v_mul_f32 v17, v17, v81
    v_mul_f32 v18, v18, v82
    v_mul_f32 v19, v19, v83
    v_mul_f32 v20, v20, v84
    v_mul_f32 v21, v21, v85
    v_mul_f32 v22, v22, v86
    buffer_load_dwordx4 v4, s[48:51], s34 offen offset:1024 lds
    v_mul_f32 v23, v23, v87
    v_mul_f32 v24, v24, v112
    v_mul_f32 v25, v25, v113
    v_mul_f32 v26, v26, v114
    v_mul_f32 v27, v27, v115
    v_mul_f32 v28, v28, v116
    v_mul_f32 v29, v29, v117
    v_mul_f32 v30, v30, v118
    v_mul_f32 v31, v31, v119
    v_exp_f32 v16, v16
    v_exp_f32 v17, v17
    v_exp_f32 v18, v18
    v_exp_f32 v19, v19
    v_exp_f32 v20, v20
    v_exp_f32 v21, v21
    v_exp_f32 v22, v22
    v_exp_f32 v23, v23
    v_exp_f32 v24, v24
    v_exp_f32 v25, v25
    s_waitcnt lgkmcnt(0)
    s_add_u32 m0, s98, 67584
    s_add_u32 s34, s17, 16384
    buffer_load_dwordx4 v3, s[48:51], s34 offen lds
    v_exp_f32 v26, v26
    v_exp_f32 v27, v27
    v_exp_f32 v28, v28
    v_exp_f32 v29, v29
    v_exp_f32 v30, v30
    v_exp_f32 v31, v31
    v_fma_f32 v16, v16, v54, v54
    v_fma_f32 v17, v17, v54, v54
    v_fma_f32 v18, v18, v54, v54
    v_fma_f32 v19, v19, v54, v54
    v_fma_f32 v20, v20, v54, v54
    v_fma_f32 v21, v21, v54, v54
    v_fma_f32 v22, v22, v54, v54
    v_fma_f32 v23, v23, v54, v54
    v_fma_f32 v24, v24, v58, v58
    v_fma_f32 v25, v25, v58, v58
    v_fma_f32 v26, v26, v58, v58
    v_fma_f32 v27, v27, v58, v58
    v_fma_f32 v28, v28, v58, v58
    v_fma_f32 v29, v29, v58, v58
    v_fma_f32 v30, v30, v58, v58
    buffer_load_dwordx4 v4, s[48:51], s34 offen offset:1024 lds
    v_fma_f32 v31, v31, v58, v58
    v_rcp_f32 v16, v16
    v_rcp_f32 v17, v17
    v_rcp_f32 v18, v18
    v_rcp_f32 v19, v19
    v_rcp_f32 v20, v20
    v_rcp_f32 v21, v21
    v_rcp_f32 v22, v22
    v_rcp_f32 v23, v23
    v_rcp_f32 v24, v24
    v_rcp_f32 v25, v25
    v_rcp_f32 v26, v26
    v_rcp_f32 v27, v27
    v_rcp_f32 v28, v28
    v_rcp_f32 v29, v29
    s_waitcnt lgkmcnt(0)
    s_add_u32 m0, s98, 69632
    s_add_u32 s34, s11, 32768
    buffer_load_dwordx4 v3, s[48:51], s34 offen lds
    v_rcp_f32 v30, v30
    v_rcp_f32 v31, v31
    v_mul_f32 v16, v16, v80
    v_mul_f32 v17, v17, v81
    v_mul_f32 v18, v18, v82
    v_mul_f32 v19, v19, v83
    v_mul_f32 v20, v20, v84
    v_mul_f32 v21, v21, v85
    v_mul_f32 v22, v22, v86
    v_mul_f32 v23, v23, v87
    v_mul_f32 v24, v24, v112
    v_mul_f32 v25, v25, v113
    v_mul_f32 v26, v26, v114
    v_mul_f32 v27, v27, v115
    v_mul_f32 v28, v28, v116
    v_mul_f32 v29, v29, v117
    v_mul_f32 v30, v30, v118
    v_mul_f32 v31, v31, v119
    v_cvt_pk_bf16_f32 v32, v16, v17
    v_cvt_pk_bf16_f32 v33, v18, v19
    v_cvt_pk_bf16_f32 v34, v20, v21
    v_cvt_pk_bf16_f32 v35, v22, v23
    v_cvt_pk_bf16_f32 v60, v24, v25
    v_cvt_pk_bf16_f32 v61, v26, v27
    v_cvt_pk_bf16_f32 v62, v28, v29
    v_cvt_pk_bf16_f32 v63, v30, v31
    buffer_load_dwordx4 v4, s[48:51], s34 offen offset:1024 lds
    buffer_store_dwordx4 v[32:35], v1, s[44:47], s99 offen sc1
    buffer_store_dwordx4 v[60:63], v2, s[44:47], s99 offen sc1
    s_add_u32 s99, s99, 28672
    v_mul_f32 v16, v88, v88
    v_mul_f32 v17, v89, v89
    v_mul_f32 v18, v90, v90
    v_mul_f32 v19, v91, v91
    v_mul_f32 v20, v92, v92
    v_mul_f32 v21, v93, v93
    v_mul_f32 v22, v94, v94
    v_mul_f32 v23, v95, v95
    v_mul_f32 v24, v120, v120
    v_mul_f32 v25, v121, v121
    v_mul_f32 v26, v122, v122
    v_mul_f32 v27, v123, v123
    v_mul_f32 v28, v124, v124
    v_mul_f32 v29, v125, v125
    v_mul_f32 v30, v126, v126
    v_mul_f32 v31, v127, v127
    v_fma_f32 v16, v16, v52, v53
    v_fma_f32 v17, v17, v52, v53
    v_fma_f32 v18, v18, v52, v53
    v_fma_f32 v19, v19, v52, v53
    v_fma_f32 v20, v20, v52, v53
    v_fma_f32 v21, v21, v52, v53
    v_fma_f32 v22, v22, v52, v53
    v_fma_f32 v23, v23, v52, v53
    v_fma_f32 v24, v24, v56, v57
    v_fma_f32 v25, v25, v56, v57
    s_waitcnt lgkmcnt(0)
    s_add_u32 m0, s98, 71680
    s_add_u32 s34, s12, 32768
    buffer_load_dwordx4 v3, s[48:51], s34 offen lds
    v_fma_f32 v26, v26, v56, v57
    v_fma_f32 v27, v27, v56, v57
    v_fma_f32 v28, v28, v56, v57
    v_fma_f32 v29, v29, v56, v57
    v_fma_f32 v30, v30, v56, v57
    v_fma_f32 v31, v31, v56, v57
    v_mul_f32 v16, v16, v88
    v_mul_f32 v17, v17, v89
    v_mul_f32 v18, v18, v90
    v_mul_f32 v19, v19, v91
    v_mul_f32 v20, v20, v92
    v_mul_f32 v21, v21, v93
    v_mul_f32 v22, v22, v94
    v_mul_f32 v23, v23, v95
    v_mul_f32 v24, v24, v120
    v_mul_f32 v25, v25, v121
    v_mul_f32 v26, v26, v122
    v_mul_f32 v27, v27, v123
    s_mov_b64 s[18:19], s[26:27]
    s_mov_b32 s62, s35
    s_mov_b32 s63, s35
    s_load_dwordx8 s[36:43], s[32:33], s101 offset:0 glc
    v_mul_f32 v28, v28, v124
    v_mul_f32 v29, v29, v125
    v_mul_f32 v30, v30, v126
    v_mul_f32 v31, v31, v127
    v_exp_f32 v16, v16
    v_exp_f32 v17, v17
    v_exp_f32 v18, v18
    buffer_load_dwordx4 v4, s[48:51], s34 offen offset:1024 lds
    v_exp_f32 v19, v19
    v_exp_f32 v20, v20
    v_exp_f32 v21, v21
    v_exp_f32 v22, v22
    v_exp_f32 v23, v23
    v_exp_f32 v24, v24
    v_exp_f32 v25, v25
    v_exp_f32 v26, v26
    v_exp_f32 v27, v27
    v_exp_f32 v28, v28
    v_exp_f32 v29, v29
    v_exp_f32 v30, v30
    v_exp_f32 v31, v31
    v_fma_f32 v16, v16, v54, v54
    v_fma_f32 v17, v17, v54, v54
    s_waitcnt vmcnt(10)
    buffer_store_dword v12, off, s[44:47], s100 offset:32 sc1
    s_load_dwordx8 s[20:27], s[32:33], s101 offset:32 glc
    v_fma_f32 v18, v18, v54, v54
    v_fma_f32 v19, v19, v54, v54
    v_fma_f32 v20, v20, v54, v54
    v_fma_f32 v21, v21, v54, v54
    v_fma_f32 v22, v22, v54, v54
    v_fma_f32 v23, v23, v54, v54
    v_fma_f32 v24, v24, v58, v58
    v_fma_f32 v25, v25, v58, v58
    v_fma_f32 v26, v26, v58, v58
    v_fma_f32 v27, v27, v58, v58
    v_fma_f32 v28, v28, v58, v58
    v_fma_f32 v29, v29, v58, v58
    v_fma_f32 v30, v30, v58, v58
    v_fma_f32 v31, v31, v58, v58
    v_rcp_f32 v16, v16
    v_rcp_f32 v17, v17
    v_rcp_f32 v18, v18
    v_rcp_f32 v19, v19
    v_rcp_f32 v20, v20
    v_rcp_f32 v21, v21
    v_rcp_f32 v22, v22
    v_rcp_f32 v23, v23
    v_rcp_f32 v24, v24
    v_rcp_f32 v25, v25
    v_rcp_f32 v26, v26
    v_rcp_f32 v27, v27
    v_rcp_f32 v28, v28
    v_rcp_f32 v29, v29
    v_rcp_f32 v30, v30
    v_rcp_f32 v31, v31
    v_mul_f32 v16, v16, v88
    v_mul_f32 v17, v17, v89
    v_mul_f32 v18, v18, v90
    v_mul_f32 v19, v19, v91
    v_mul_f32 v20, v20, v92
    v_mul_f32 v21, v21, v93
    v_mul_f32 v22, v22, v94
    v_mul_f32 v23, v23, v95
    v_mul_f32 v24, v24, v120
    v_mul_f32 v25, v25, v121
    v_mul_f32 v26, v26, v122
    v_mul_f32 v27, v27, v123
    v_mul_f32 v28, v28, v124
    v_mul_f32 v29, v29, v125
    v_mul_f32 v30, v30, v126
    v_mul_f32 v31, v31, v127
    v_cvt_pk_bf16_f32 v32, v16, v17
    v_cvt_pk_bf16_f32 v33, v18, v19
    v_cvt_pk_bf16_f32 v34, v20, v21
    v_cvt_pk_bf16_f32 v35, v22, v23
    v_cvt_pk_bf16_f32 v60, v24, v25
    v_cvt_pk_bf16_f32 v61, v26, v27
    v_cvt_pk_bf16_f32 v62, v28, v29
    v_cvt_pk_bf16_f32 v63, v30, v31
    buffer_store_dwordx4 v[32:35], v1, s[44:47], s99 offen sc1
    buffer_store_dwordx4 v[60:63], v2, s[44:47], s99 offen sc1
    s_add_u32 s99, s99, 28672
Ljoin:
    s_waitcnt lgkmcnt(0)
    s_waitcnt vmcnt(5)
    buffer_store_dword v12, off, s[44:47], s100 offset:64 sc1
    s_waitcnt lgkmcnt(0)
    s_xor_b64 s[36:37], s[36:37], s[62:63]
    s_xor_b64 s[38:39], s[38:39], s[62:63]
    s_xor_b64 s[40:41], s[40:41], s[62:63]
    s_xor_b32 s42, s42, s62
    s_or_b64 s[36:37], s[36:37], s[38:39]
    s_or_b32 s40, s40, s42
    s_or_b64 s[36:37], s[36:37], s[40:41]
    s_cbranch_scc1 Lhs_1030
Lhb_1031:
    buffer_load_dwordx4 v[16:19], v14, s[44:47], s4 offen sc1
    buffer_load_dwordx4 v[20:23], v15, s[44:47], s4 offen sc1
    s_add_u32 s4, s4, 28672
    buffer_load_dwordx4 v[24:27], v14, s[44:47], s5 offen sc1
    buffer_load_dwordx4 v[28:31], v15, s[44:47], s5 offen sc1
    s_add_u32 s5, s5, 28672
    buffer_load_dwordx4 v[32:35], v14, s[44:47], s6 offen sc1
    buffer_load_dwordx4 v[36:39], v15, s[44:47], s6 offen sc1
    s_add_u32 s6, s6, 28672
    buffer_load_dwordx4 v[40:43], v14, s[44:47], s7 offen sc1
    buffer_load_dwordx4 v[44:47], v15, s[44:47], s7 offen sc1
    s_add_u32 s7, s7, 28672
    buffer_load_dwordx4 v[48:51], v14, s[44:47], s8 offen sc1
    buffer_load_dwordx4 v[52:55], v15, s[44:47], s8 offen sc1
    s_add_u32 s8, s8, 28672
    buffer_load_dwordx4 v[56:59], v14, s[44:47], s9 offen sc1
    buffer_load_dwordx4 v[60:63], v15, s[44:47], s9 offen sc1
    s_add_u32 s9, s9, 28672
    buffer_load_dwordx4 v[224:227], v14, s[44:47], s10 offen sc1
    buffer_load_dwordx4 v[228:231], v15, s[44:47], s10 offen sc1
    s_add_u32 s10, s10, 28672
    s_waitcnt lgkmcnt(0)
    s_xor_b64 s[20:21], s[20:21], s[62:63]
    s_xor_b64 s[22:23], s[22:23], s[62:63]
    s_xor_b64 s[24:25], s[24:25], s[62:63]
    s_xor_b32 s26, s26, s62
    s_or_b64 s[20:21], s[20:21], s[22:23]
    s_or_b32 s24, s24, s26
    s_or_b64 s[20:21], s[20:21], s[24:25]
    s_cbranch_scc1 Lhs_1033
Lhb_1034:
    buffer_load_dwordx4 v[232:235], v14, s[44:47], s4 offen sc1
    buffer_load_dwordx4 v[236:239], v15, s[44:47], s4 offen sc1
    s_add_u32 s4, s4, 28672
    buffer_load_dwordx4 v[240:243], v14, s[44:47], s5 offen sc1
    buffer_load_dwordx4 v[244:247], v15, s[44:47], s5 offen sc1
    s_add_u32 s5, s5, 28672
    buffer_load_dwordx4 v[248:251], v14, s[44:47], s6 offen sc1
    buffer_load_dwordx4 v[252:255], v15, s[44:47], s6 offen sc1
    s_add_u32 s6, s6, 28672
    s_waitcnt vmcnt(21)
    buffer_store_dword v12, off, s[44:47], s100 offset:96 sc1
    s_add_u32 m0, s98, 0
    s_add_u32 s34, s13, 32768
    buffer_load_dwordx4 v3, s[48:51], s34 offen lds
    buffer_load_dwordx4 v4, s[48:51], s34 offen offset:1024 lds
    s_add_u32 m0, s98, 2048
    s_add_u32 s34, s14, 32768
    buffer_load_dwordx4 v3, s[48:51], s34 offen lds
    buffer_load_dwordx4 v4, s[48:51], s34 offen offset:1024 lds
    s_add_u32 m0, s98, 4096
    s_add_u32 s34, s15, 32768
    buffer_load_dwordx4 v3, s[48:51], s34 offen lds
    buffer_load_dwordx4 v4, s[48:51], s34 offen offset:1024 lds
    s_add_u32 m0, s98, 6144
    s_add_u32 s34, s16, 32768
    buffer_load_dwordx4 v3, s[48:51], s34 offen lds
    buffer_load_dwordx4 v4, s[48:51], s34 offen offset:1024 lds
    s_waitcnt vmcnt(54)
    ds_read_b64_tr_b16 v[192:193], v5 offset:32768
    ds_read_b64_tr_b16 v[194:195], v5 offset:33792
    ds_read_b64_tr_b16 v[196:197], v6 offset:32768
    ds_read_b64_tr_b16 v[198:199], v6 offset:33792
    s_waitcnt vmcnt(52)
    ds_read_b64_tr_b16 v[200:201], v5 offset:34816
    ds_read_b64_tr_b16 v[202:203], v5 offset:35840
    ds_read_b64_tr_b16 v[204:205], v6 offset:34816
    ds_read_b64_tr_b16 v[206:207], v6 offset:35840
    s_waitcnt vmcnt(50)
    ds_read_b64_tr_b16 v[208:209], v5 offset:36864
    ds_read_b64_tr_b16 v[210:211], v5 offset:37888
    ds_read_b64_tr_b16 v[212:213], v6 offset:36864
    ds_read_b64_tr_b16 v[214:215], v6 offset:37888
    s_waitcnt vmcnt(48)
    ds_read_b64_tr_b16 v[216:217], v5 offset:38912
    ds_read_b64_tr_b16 v[218:219], v5 offset:39936
    ds_read_b64_tr_b16 v[220:221], v6 offset:38912
    ds_read_b64_tr_b16 v[222:223], v6 offset:39936
    s_waitcnt vmcnt(27) lgkmcnt(0)
    v_mfma_f32_32x32x16_bf16 v[64:79], v[128:131], v[16:19], 0
    s_add_u32 m0, s98, 32768
    s_add_u32 s34, s17, 32768
    buffer_load_dwordx4 v3, s[48:51], s34 offen lds
    buffer_load_dwordx4 v4, s[48:51], s34 offen offset:1024 lds
    v_mfma_f32_32x32x16_bf16 v[80:95], v[128:131], v[20:23], 0
    v_mfma_f32_32x32x16_bf16 v[96:111], v[132:135], v[16:19], 0
    v_mfma_f32_32x32x16_bf16 v[112:127], v[132:135], v[20:23], 0
    s_waitcnt vmcnt(27)
    v_mfma_f32_32x32x16_bf16 v[64:79], v[136:139], v[24:27], v[64:79]
    s_load_dwordx8 s[36:43], s[32:33], s101 offset:64 glc
    buffer_load_dwordx4 v[16:19], v14, s[44:47], s7 offen sc1
    buffer_load_dwordx4 v[20:23], v15, s[44:47], s7 offen sc1
    s_add_u32 s7, s7, 28672
    v_mfma_f32_32x32x16_bf16 v[80:95], v[136:139], v[28:31], v[80:95]
    buffer_load_dwordx4 v[128:131], v14, s[44:47], s8 offen sc1
    buffer_load_dwordx4 v[132:135], v15, s[44:47], s8 offen sc1
    s_add_u32 s8, s8, 28672
    v_mfma_f32_32x32x16_bf16 v[96:111], v[140:143], v[24:27], v[96:111]
    s_add_u32 m0, s98, 34816
    s_add_u32 s34, s11, 49152
    buffer_load_dwordx4 v3, s[48:51], s34 offen lds
    buffer_load_dwordx4 v4, s[48:51], s34 offen offset:1024 lds
    v_mfma_f32_32x32x16_bf16 v[112:127], v[140:143], v[28:31], v[112:127]
    s_waitcnt vmcnt(31)
    v_mfma_f32_32x32x16_bf16 v[64:79], v[144:147], v[32:35], v[64:79]
    buffer_load_dwordx4 v[24:27], v14, s[44:47], s9 offen sc1
    buffer_load_dwordx4 v[28:31], v15, s[44:47], s9 offen sc1
    s_add_u32 s9, s9, 28672
    v_mfma_f32_32x32x16_bf16 v[80:95], v[144:147], v[36:39], v[80:95]
    buffer_load_dwordx4 v[136:139], v14, s[44:47], s10 offen sc1
    buffer_load_dwordx4 v[140:143], v15, s[44:47], s10 offen sc1
    s_add_u32 s10, s10, 28672
    v_mfma_f32_32x32x16_bf16 v[96:111], v[148:151], v[32:35], v[96:111]
    s_add_u32 m0, s98, 36864
    s_add_u32 s34, s12, 49152
    buffer_load_dwordx4 v3, s[48:51], s34 offen lds
    buffer_load_dwordx4 v4, s[48:51], s34 offen offset:1024 lds
    v_mfma_f32_32x32x16_bf16 v[112:127], v[148:151], v[36:39], v[112:127]
    s_waitcnt vmcnt(35)
    v_mfma_f32_32x32x16_bf16 v[64:79], v[152:155], v[40:43], v[64:79]
    s_waitcnt lgkmcnt(0)
    s_xor_b64 s[36:37], s[36:37], s[62:63]
    s_xor_b64 s[38:39], s[38:39], s[62:63]
    s_xor_b64 s[40:41], s[40:41], s[62:63]
    s_xor_b32 s42, s42, s62
    s_or_b64 s[36:37], s[36:37], s[38:39]
    s_or_b32 s40, s40, s42
    s_or_b64 s[36:37], s[36:37], s[40:41]
    s_cbranch_scc1 Lhs_1036
Lhb_1037:
    buffer_load_dwordx4 v[32:35], v14, s[44:47], s4 offen sc1
    buffer_load_dwordx4 v[36:39], v15, s[44:47], s4 offen sc1
    s_add_u32 s4, s4, 28672
    v_mfma_f32_32x32x16_bf16 v[80:95], v[152:155], v[44:47], v[80:95]
    buffer_load_dwordx4 v[144:147], v14, s[44:47], s5 offen sc1
    buffer_load_dwordx4 v[148:151], v15, s[44:47], s5 offen sc1
    s_add_u32 s5, s5, 28672
    v_mfma_f32_32x32x16_bf16 v[96:111], v[156:159], v[40:43], v[96:111]
    s_add_u32 m0, s98, 38912
    s_add_u32 s34, s13, 49152
    buffer_load_dwordx4 v3, s[48:51], s34 offen lds
    buffer_load_dwordx4 v4, s[48:51], s34 offen offset:1024 lds
    v_mfma_f32_32x32x16_bf16 v[112:127], v[156:159], v[44:47], v[112:127]
    s_waitcnt vmcnt(39)
    v_mfma_f32_32x32x16_bf16 v[64:79], v[160:163], v[48:51], v[64:79]
    buffer_load_dwordx4 v[40:43], v14, s[44:47], s6 offen sc1
    buffer_load_dwordx4 v[44:47], v15, s[44:47], s6 offen sc1
    s_add_u32 s6, s6, 28672
    v_mfma_f32_32x32x16_bf16 v[80:95], v[160:163], v[52:55], v[80:95]
    s_mov_b64 exec, 1
    ds_add_u32 v9, v10 offset:8
    s_mov_b64 exec, -1
    v_mfma_f32_32x32x16_bf16 v[96:111], v[164:167], v[48:51], v[96:111]
    v_mfma_f32_32x32x16_bf16 v[112:127], v[164:167], v[52:55], v[112:127]
    s_waitcnt vmcnt(39)
    v_mfma_f32_32x32x16_bf16 v[64:79], v[168:171], v[56:59], v[64:79]
    s_load_dwordx8 s[20:27], s[32:33], s101 offset:96 glc
    buffer_load_dwordx4 v[152:155], v14, s[44:47], s7 offen sc1
    buffer_load_dwordx4 v[156:159], v15, s[44:47], s7 offen sc1
    s_add_u32 s7, s7, 28672
    v_mfma_f32_32x32x16_bf16 v[80:95], v[168:171], v[60:63], v[80:95]
    v_mfma_f32_32x32x16_bf16 v[96:111], v[172:175], v[56:59], v[96:111]
    v_mfma_f32_32x32x16_bf16 v[112:127], v[172:175], v[60:63], v[112:127]
    s_waitcnt vmcnt(39)
    v_mfma_f32_32x32x16_bf16 v[64:79], v[176:179], v[224:227], v[64:79]
    buffer_load_dwordx4 v[48:51], v14, s[44:47], s8 offen sc1
    buffer_load_dwordx4 v[52:55], v15, s[44:47], s8 offen sc1
    s_add_u32 s8, s8, 28672
    v_mfma_f32_32x32x16_bf16 v[80:95], v[176:179], v[228:231], v[80:95]
    v_mfma_f32_32x32x16_bf16 v[96:111], v[180:183], v[224:227], v[96:111]
    v_mfma_f32_32x32x16_bf16 v[112:127], v[180:183], v[228:231], v[112:127]
    s_waitcnt vmcnt(39)
    v_mfma_f32_32x32x16_bf16 v[64:79], v[184:187], v[232:235], v[64:79]
    buffer_load_dwordx4 v[160:163], v14, s[44:47], s9 offen sc1
    buffer_load_dwordx4 v[164:167], v15, s[44:47], s9 offen sc1
    s_add_u32 s9, s9, 28672
    v_mfma_f32_32x32x16_bf16 v[80:95], v[184:187], v[236:239], v[80:95]
    v_mfma_f32_32x32x16_bf16 v[96:111], v[188:191], v[232:235], v[96:111]
    v_mfma_f32_32x32x16_bf16 v[112:127], v[188:191], v[236:239], v[112:127]
    s_waitcnt vmcnt(39)
    v_mfma_f32_32x32x16_bf16 v[64:79], v[192:195], v[240:243], v[64:79]
    buffer_load_dwordx4 v[56:59], v14, s[44:47], s10 offen sc1
    buffer_load_dwordx4 v[60:63], v15, s[44:47], s10 offen sc1
    s_add_u32 s10, s10, 28672
    v_mfma_f32_32x32x16_bf16 v[80:95], v[192:195], v[244:247], v[80:95]
    v_mfma_f32_32x32x16_bf16 v[96:111], v[196:199], v[240:243], v[96:111]
    v_mfma_f32_32x32x16_bf16 v[112:127], v[196:199], v[244:247], v[112:127]
    s_waitcnt vmcnt(39)
    v_mfma_f32_32x32x16_bf16 v[64:79], v[200:203], v[248:251], v[64:79]
    s_waitcnt lgkmcnt(0)
    s_xor_b64 s[20:21], s[20:21], s[62:63]
    s_xor_b64 s[22:23], s[22:23], s[62:63]
    s_xor_b64 s[24:25], s[24:25], s[62:63]
    s_xor_b32 s26, s26, s62
    s_or_b64 s[20:21], s[20:21], s[22:23]
    s_or_b32 s24, s24, s26
    s_or_b64 s[20:21], s[20:21], s[24:25]
    s_cbranch_scc1 Lhs_1039
Lhb_1040:
    buffer_load_dwordx4 v[168:171], v14, s[44:47], s4 offen sc1
    buffer_load_dwordx4 v[172:175], v15, s[44:47], s4 offen sc1
    v_mfma_f32_32x32x16_bf16 v[80:95], v[200:203], v[252:255], v[80:95]
    v_mfma_f32_32x32x16_bf16 v[96:111], v[204:207], v[248:251], v[96:111]
    v_mfma_f32_32x32x16_bf16 v[112:127], v[204:207], v[252:255], v[112:127]
    s_waitcnt vmcnt(28)
    v_mfma_f32_32x32x16_bf16 v[64:79], v[208:211], v[16:19], v[64:79]
    ds_read_b64_tr_b16 v[224:225], v7 offset:0
    ds_read_b64_tr_b16 v[226:227], v7 offset:1024
    ds_read_b64_tr_b16 v[228:229], v8 offset:0
    ds_read_b64_tr_b16 v[230:231], v8 offset:1024
    v_mfma_f32_32x32x16_bf16 v[80:95], v[208:211], v[20:23], v[80:95]
    buffer_load_dwordx4 v[176:179], v14, s[44:47], s5 offen sc1
    buffer_load_dwordx4 v[180:183], v15, s[44:47], s5 offen sc1
    v_mfma_f32_32x32x16_bf16 v[96:111], v[212:215], v[16:19], v[96:111]
    v_mfma_f32_32x32x16_bf16 v[112:127], v[212:215], v[20:23], v[112:127]
    s_waitcnt vmcnt(28)
    v_mfma_f32_32x32x16_bf16 v[64:79], v[216:219], v[128:131], v[64:79]
    ds_read_b64_tr_b16 v[232:233], v7 offset:2048
    ds_read_b64_tr_b16 v[234:235], v7 offset:3072
    ds_read_b64_tr_b16 v[236:237], v8 offset:2048
    ds_read_b64_tr_b16 v[238:239], v8 offset:3072
    v_mfma_f32_32x32x16_bf16 v[80:95], v[216:219], v[132:135], v[80:95]
    buffer_load_dwordx4 v[184:187], v14, s[44:47], s6 offen sc1
    buffer_load_dwordx4 v[188:191], v15, s[44:47], s6 offen sc1
    v_mfma_f32_32x32x16_bf16 v[96:111], v[220:223], v[128:131], v[96:111]
    v_mfma_f32_32x32x16_bf16 v[112:127], v[220:223], v[132:135], v[112:127]
    s_waitcnt vmcnt(26) lgkmcnt(4)
    v_mfma_f32_32x32x16_bf16 v[64:79], v[224:227], v[24:27], v[64:79]
    ds_read_b64_tr_b16 v[240:241], v7 offset:4096
    ds_read_b64_tr_b16 v[242:243], v7 offset:5120
    ds_read_b64_tr_b16 v[244:245], v8 offset:4096
    ds_read_b64_tr_b16 v[246:247], v8 offset:5120
    v_mfma_f32_32x32x16_bf16 v[80:95], v[224:227], v[28:31], v[80:95]
    buffer_load_dwordx4 v[192:195], v14, s[44:47], s7 offen sc1
    buffer_load_dwordx4 v[196:199], v15, s[44:47], s7 offen sc1
    v_mfma_f32_32x32x16_bf16 v[96:111], v[228:231], v[24:27], v[96:111]
    s_add_u32 m0, s98, 65536
    s_add_u32 s34, s14, 49152
    buffer_load_dwordx4 v3, s[48:51], s34 offen lds
    buffer_load_dwordx4 v4, s[48:51], s34 offen offset:1024 lds
    v_mfma_f32_32x32x16_bf16 v[112:127], v[228:231], v[28:31], v[112:127]
    s_waitcnt vmcnt(28) lgkmcnt(4)
    v_mfma_f32_32x32x16_bf16 v[64:79], v[232:235], v[136:139], v[64:79]
    ds_read_b64_tr_b16 v[248:249], v7 offset:6144
    ds_read_b64_tr_b16 v[250:251], v7 offset:7168
    ds_read_b64_tr_b16 v[252:253], v8 offset:6144
    ds_read_b64_tr_b16 v[254:255], v8 offset:7168
    v_mfma_f32_32x32x16_bf16 v[80:95], v[232:235], v[140:143], v[80:95]
    buffer_load_dwordx4 v[200:203], v14, s[44:47], s8 offen sc1
    buffer_load_dwordx4 v[204:207], v15, s[44:47], s8 offen sc1
    v_mfma_f32_32x32x16_bf16 v[96:111], v[236:239], v[136:139], v[96:111]
    s_add_u32 m0, s98, 67584
    s_add_u32 s34, s15, 49152
    buffer_load_dwordx4 v3, s[48:51], s34 offen lds
    buffer_load_dwordx4 v4, s[48:51], s34 offen offset:1024 lds
    v_mfma_f32_32x32x16_bf16 v[112:127], v[236:239], v[140:143], v[112:127]
    s_waitcnt vmcnt(28) lgkmcnt(4)
    v_mfma_f32_32x32x16_bf16 v[64:79], v[240:243], v[32:35], v[64:79]
    s_waitcnt vmcnt(50)
    ds_read_b64_tr_b16 v[16:17], v5 offset:0
    ds_read_b64_tr_b16 v[18:19], v5 offset:1024
    ds_read_b64_tr_b16 v[20:21], v6 offset:0
    ds_read_b64_tr_b16 v[22:23], v6 offset:1024
    v_mfma_f32_32x32x16_bf16 v[80:95], v[240:243], v[36:39], v[80:95]
    buffer_load_dwordx4 v[208:211], v14, s[44:47], s9 offen sc1
    buffer_load_dwordx4 v[212:215], v15, s[44:47], s9 offen sc1
    v_mfma_f32_32x32x16_bf16 v[96:111], v[244:247], v[32:35], v[96:111]
    s_add_u32 m0, s98, 69632
    s_add_u32 s34, s16, 49152
    buffer_load_dwordx4 v3, s[48:51], s34 offen lds
    buffer_load_dwordx4 v4, s[48:51], s34 offen offset:1024 lds
    v_mfma_f32_32x32x16_bf16 v[112:127], v[244:247], v[36:39], v[112:127]
    s_waitcnt vmcnt(30) lgkmcnt(4)
    v_mfma_f32_32x32x16_bf16 v[64:79], v[248:251], v[144:147], v[64:79]
    s_waitcnt vmcnt(52)
    ds_read_b64_tr_b16 v[128:129], v5 offset:2048
    ds_read_b64_tr_b16 v[130:131], v5 offset:3072
    ds_read_b64_tr_b16 v[132:133], v6 offset:2048
    ds_read_b64_tr_b16 v[134:135], v6 offset:3072
    v_mfma_f32_32x32x16_bf16 v[80:95], v[248:251], v[148:151], v[80:95]
    buffer_load_dwordx4 v[216:219], v14, s[44:47], s10 offen sc1
    buffer_load_dwordx4 v[220:223], v15, s[44:47], s10 offen sc1
    v_mfma_f32_32x32x16_bf16 v[96:111], v[252:255], v[144:147], v[96:111]
    s_add_u32 m0, s98, 71680
    s_add_u32 s34, s17, 49152
    buffer_load_dwordx4 v3, s[48:51], s34 offen lds
    buffer_load_dwordx4 v4, s[48:51], s34 offen offset:1024 lds
    v_mfma_f32_32x32x16_bf16 v[112:127], v[252:255], v[148:151], v[112:127]
    s_waitcnt vmcnt(30) lgkmcnt(4)
    v_mfma_f32_32x32x16_bf16 v[64:79], v[16:19], v[40:43], v[64:79]
    s_waitcnt vmcnt(54)
    ds_read_b64_tr_b16 v[24:25], v5 offset:4096
    ds_read_b64_tr_b16 v[26:27], v5 offset:5120
    ds_read_b64_tr_b16 v[28:29], v6 offset:4096
    ds_read_b64_tr_b16 v[30:31], v6 offset:5120
    v_mfma_f32_32x32x16_bf16 v[80:95], v[16:19], v[44:47], v[80:95]
    v_mfma_f32_32x32x16_bf16 v[96:111], v[20:23], v[40:43], v[96:111]
    v_mfma_f32_32x32x16_bf16 v[112:127], v[20:23], v[44:47], v[112:127]
    s_waitcnt vmcnt(28) lgkmcnt(4)
    v_mfma_f32_32x32x16_bf16 v[64:79], v[128:131], v[152:155], v[64:79]
    s_waitcnt vmcnt(52)
    ds_read_b64_tr_b16 v[224:225], v5 offset:6144
    ds_read_b64_tr_b16 v[226:227], v5 offset:7168
    ds_read_b64_tr_b16 v[228:229], v6 offset:6144
    ds_read_b64_tr_b16 v[230:231], v6 offset:7168
    v_mfma_f32_32x32x16_bf16 v[80:95], v[128:131], v[156:159], v[80:95]
    v_mfma_f32_32x32x16_bf16 v[96:111], v[132:135], v[152:155], v[96:111]
    v_mfma_f32_32x32x16_bf16 v[112:127], v[132:135], v[156:159], v[112:127]
    s_waitcnt vmcnt(26) lgkmcnt(4)
    v_mfma_f32_32x32x16_bf16 v[64:79], v[24:27], v[48:51], v[64:79]
    s_waitcnt vmcnt(50)
    ds_read_b64_tr_b16 v[136:137], v5 offset:32768
    ds_read_b64_tr_b16 v[138:139], v5 offset:33792
    ds_read_b64_tr_b16 v[140:141], v6 offset:32768
    ds_read_b64_tr_b16 v[142:143], v6 offset:33792
    v_mfma_f32_32x32x16_bf16 v[80:95], v[24:27], v[52:55], v[80:95]
    v_mfma_f32_32x32x16_bf16 v[96:111], v[28:31], v[48:51], v[96:111]
    v_mfma_f32_32x32x16_bf16 v[112:127], v[28:31], v[52:55], v[112:127]
    s_waitcnt vmcnt(24) lgkmcnt(4)
    v_mfma_f32_32x32x16_bf16 v[64:79], v[224:227], v[160:163], v[64:79]
    s_waitcnt vmcnt(44)
    ds_read_b64_tr_b16 v[232:233], v5 offset:34816
    ds_read_b64_tr_b16 v[234:235], v5 offset:35840
    ds_read_b64_tr_b16 v[236:237], v6 offset:34816
    ds_read_b64_tr_b16 v[238:239], v6 offset:35840
    v_mfma_f32_32x32x16_bf16 v[80:95], v[224:227], v[164:167], v[80:95]
    v_mfma_f32_32x32x16_bf16 v[96:111], v[228:231], v[160:163], v[96:111]
    v_mfma_f32_32x32x16_bf16 v[112:127], v[228:231], v[164:167], v[112:127]
    s_waitcnt vmcnt(22) lgkmcnt(4)
    v_mfma_f32_32x32x16_bf16 v[64:79], v[136:139], v[56:59], v[64:79]
    s_waitcnt vmcnt(38)
    ds_read_b64_tr_b16 v[32:33], v5 offset:36864
    ds_read_b64_tr_b16 v[34:35], v5 offset:37888
    ds_read_b64_tr_b16 v[36:37], v6 offset:36864
    ds_read_b64_tr_b16 v[38:39], v6 offset:37888
    v_mfma_f32_32x32x16_bf16 v[80:95], v[136:139], v[60:63], v[80:95]
    v_mfma_f32_32x32x16_bf16 v[96:111], v[140:143], v[56:59], v[96:111]
    v_mfma_f32_32x32x16_bf16 v[112:127], v[140:143], v[60:63], v[112:127]
    s_and_b32 s60, s3, 1
    s_lshl_b32 s60, s60, 6
    s_lshl_b32 s61, s57, 7
    s_add_u32 s60, s60, s61
    v_lshrrev_b32 v3, 5, v0
    v_lshlrev_b32 v3, 4, v3
    v_add_u32 v3, s60, v3
    global_load_dwordx4 v[40:43], v3, s[18:19]
    global_load_dwordx4 v[44:47], v3, s[18:19] offset:32
    s_waitcnt vmcnt(22) lgkmcnt(4)
    v_mfma_f32_32x32x16_bf16 v[64:79], v[232:235], v[168:171], v[64:79]
    s_waitcnt vmcnt(34)
    ds_read_b64_tr_b16 v[240:241], v5 offset:38912
    ds_read_b64_tr_b16 v[242:243], v5 offset:39936
    ds_read_b64_tr_b16 v[244:245], v6 offset:38912
    ds_read_b64_tr_b16 v[246:247], v6 offset:39936
    v_mfma_f32_32x32x16_bf16 v[80:95], v[232:235], v[172:175], v[80:95]
    s_waitcnt vmcnt(14)
    ds_read_b64_tr_b16 v[144:145], v7 offset:0
    ds_read_b64_tr_b16 v[146:147], v7 offset:1024
    ds_read_b64_tr_b16 v[148:149], v8 offset:0
    ds_read_b64_tr_b16 v[150:151], v8 offset:1024
    v_mfma_f32_32x32x16_bf16 v[96:111], v[236:239], v[168:171], v[96:111]
    s_waitcnt vmcnt(10)
    ds_read_b64_tr_b16 v[248:249], v7 offset:2048
    ds_read_b64_tr_b16 v[250:251], v7 offset:3072
    ds_read_b64_tr_b16 v[252:253], v8 offset:2048
    ds_read_b64_tr_b16 v[254:255], v8 offset:3072
    v_mfma_f32_32x32x16_bf16 v[112:127], v[236:239], v[172:175], v[112:127]
    s_waitcnt vmcnt(20) lgkmcnt(12)
    v_mfma_f32_32x32x16_bf16 v[64:79], v[32:35], v[176:179], v[64:79]
    s_waitcnt vmcnt(6)
    ds_read_b64_tr_b16 v[16:17], v7 offset:4096
    ds_read_b64_tr_b16 v[18:19], v7 offset:5120
    ds_read_b64_tr_b16 v[20:21], v8 offset:4096
    ds_read_b64_tr_b16 v[22:23], v8 offset:5120
    v_mfma_f32_32x32x16_bf16 v[80:95], v[32:35], v[180:183], v[80:95]
    v_mfma_f32_32x32x16_bf16 v[96:111], v[36:39], v[176:179], v[96:111]
    v_mfma_f32_32x32x16_bf16 v[112:127], v[36:39], v[180:183], v[112:127]
    s_waitcnt vmcnt(18) lgkmcnt(12)
    v_mfma_f32_32x32x16_bf16 v[64:79], v[240:243], v[184:187], v[64:79]
    s_waitcnt vmcnt(2)
    ds_read_b64_tr_b16 v[152:153], v7 offset:6144
    ds_read_b64_tr_b16 v[154:155], v7 offset:7168
    ds_read_b64_tr_b16 v[156:157], v8 offset:6144
    ds_read_b64_tr_b16 v[158:159], v8 offset:7168
    v_mfma_f32_32x32x16_bf16 v[80:95], v[240:243], v[188:191], v[80:95]
    v_mfma_f32_32x32x16_bf16 v[96:111], v[244:247], v[184:187], v[96:111]
    v_mfma_f32_32x32x16_bf16 v[112:127], v[244:247], v[188:191], v[112:127]
    s_waitcnt vmcnt(4) lgkmcnt(0)
    v_mfma_f32_32x32x16_bf16 v[96:111], v[148:151], v[192:195], v[96:111]
    v_add_u32 v5, s98, v1
    v_add_u32 v6, 0x10000, v5
    v_xor_b32 v7, 8192, v5
    v_xor_b32 v8, 16384, v5
    v_xor_b32 v4, 24576, v6
    v_and_b32 v11, 31, v0
    s_lshr_b32 s60, s3, 1
    v_mfma_f32_32x32x16_bf16 v[96:111], v[252:255], v[200:203], v[96:111]
    s_lshl_b32 s60, s60, 5
    v_add_u32 v11, s60, v11
    v_lshrrev_b32 v13, 5, v0
    s_and_b32 s61, s3, 1
    s_lshl_b32 s61, s61, 2
    v_add_u32 v13, s61, v13
    v_and_b32 v14, 7, v0
    v_mfma_f32_32x32x16_bf16 v[96:111], v[20:23], v[208:211], v[96:111]
    v_xor_b32 v14, v14, v13
    v_lshlrev_b32 v14, 4, v14
    v_lshl_add_u32 v14, v11, 7, v14
    v_add_u32 v14, 142976, v14
    v_lshlrev_b32 v15, 10, v11
    v_lshl_add_u32 v15, v13, 4, v15
    s_lshl_b32 s62, s56, 16
    v_mfma_f32_32x32x16_bf16 v[96:111], v[156:159], v[216:219], v[96:111]
    s_lshl_b32 s61, s57, 7
    s_add_u32 s62, s62, s61
    s_mov_b32 s36, s28
    s_mov_b32 s37, s29
    s_mov_b32 s38, 2097152
    s_mov_b32 s39, 0x20000
    v_mfma_f32_32x32x16_bf16 v[80:95], v[144:147], v[196:199], v[80:95]
    v_mfma_f32_32x32x16_bf16 v[80:95], v[248:251], v[204:207], v[80:95]
    s_nop 3
    ds_write_b128 v5, v[96:99] offset:0
    ds_write_b128 v5, v[100:103] offset:1024
    v_mfma_f32_32x32x16_bf16 v[80:95], v[16:19], v[212:215], v[80:95]
    ds_write_b128 v5, v[104:107] offset:2048
    ds_write_b128 v5, v[108:111] offset:3072
    v_mfma_f32_32x32x16_bf16 v[80:95], v[152:155], v[220:223], v[80:95]
    v_mfma_f32_32x32x16_bf16 v[112:127], v[148:151], v[196:199], v[112:127]
    v_mfma_f32_32x32x16_bf16 v[112:127], v[252:255], v[204:207], v[112:127]
    s_nop 7
    s_nop 1
    ds_write_b128 v5, v[80:83] offset:32768
    ds_write_b128 v5, v[84:87] offset:33792
    v_mfma_f32_32x32x16_bf16 v[112:127], v[20:23], v[212:215], v[112:127]
    ds_write_b128 v5, v[88:91] offset:34816
    ds_write_b128 v5, v[92:95] offset:35840
    v_mfma_f32_32x32x16_bf16 v[112:127], v[156:159], v[220:223], v[112:127]
    v_mfma_f32_32x32x16_bf16 v[64:79], v[144:147], v[192:195], v[64:79]
    v_mfma_f32_32x32x16_bf16 v[64:79], v[248:251], v[200:203], v[64:79]
    s_nop 7
    s_nop 1
    ds_write_b128 v6, v[112:115] offset:0
    ds_write_b128 v6, v[116:119] offset:1024
    v_mfma_f32_32x32x16_bf16 v[64:79], v[16:19], v[208:211], v[64:79]
    ds_write_b128 v6, v[120:123] offset:2048
    ds_write_b128 v6, v[124:127] offset:3072
    v_mfma_f32_32x32x16_bf16 v[64:79], v[152:155], v[216:219], v[64:79]
    s_waitcnt lgkmcnt(0)
    s_mov_b64 exec, 1
    ds_add_u32 v9, v10 offset:12
    s_mov_b64 exec, -1
    s_mov_b32 s94, 65536
Lw_1042:
    ds_read_b32 v11, v9 offset:12
    s_waitcnt lgkmcnt(0)
    v_cmp_gt_u32 vcc, 8, v11
    s_cbranch_vccz Lwd_1043
    s_sub_u32 s94, s94, 1
    s_cbranch_scc0 Lw_1042
Lwd_1043:
    v_xor_b32 v11, 32, v14
    ds_read_b128 v[200:203], v14
    ds_read_b128 v[204:207], v11
    ds_read_b128 v[128:131], v7 offset:0
    ds_read_b128 v[132:135], v7 offset:1024
    ds_read_b128 v[136:139], v7 offset:2048
    ds_read_b128 v[140:143], v7 offset:3072
    ds_read_b128 v[144:147], v8 offset:32768
    ds_read_b128 v[148:151], v8 offset:33792
    ds_read_b128 v[152:155], v8 offset:34816
    ds_read_b128 v[156:159], v8 offset:35840
    ds_read_b128 v[160:163], v4 offset:0
    ds_read_b128 v[164:167], v4 offset:1024
    ds_read_b128 v[168:171], v4 offset:2048
    ds_read_b128 v[172:175], v4 offset:3072
    s_waitcnt vmcnt(0)
    v_lshlrev_b32 v176, 16, v40
    v_and_b32 v177, 0xffff0000, v40
    v_lshlrev_b32 v178, 16, v41
    v_and_b32 v179, 0xffff0000, v41
    v_lshlrev_b32 v180, 16, v42
    v_and_b32 v181, 0xffff0000, v42
    v_lshlrev_b32 v182, 16, v43
    v_and_b32 v183, 0xffff0000, v43
    v_lshlrev_b32 v184, 16, v44
    v_and_b32 v185, 0xffff0000, v44
    v_lshlrev_b32 v186, 16, v45
    v_and_b32 v187, 0xffff0000, v45
    v_lshlrev_b32 v188, 16, v46
    v_and_b32 v189, 0xffff0000, v46
    v_lshlrev_b32 v190, 16, v47
    v_and_b32 v191, 0xffff0000, v47
    s_waitcnt lgkmcnt(12)
    v_lshlrev_b32 v208, 16, v200
    v_and_b32 v209, 0xffff0000, v200
    v_lshlrev_b32 v210, 16, v201
    v_and_b32 v211, 0xffff0000, v201
    v_lshlrev_b32 v212, 16, v202
    v_and_b32 v213, 0xffff0000, v202
    v_lshlrev_b32 v214, 16, v203
    v_and_b32 v215, 0xffff0000, v203
    v_lshlrev_b32 v216, 16, v204
    v_and_b32 v217, 0xffff0000, v204
    v_lshlrev_b32 v218, 16, v205
    v_and_b32 v219, 0xffff0000, v205
    v_lshlrev_b32 v220, 16, v206
    v_and_b32 v221, 0xffff0000, v206
    v_lshlrev_b32 v222, 16, v207
    v_and_b32 v223, 0xffff0000, v207
    s_waitcnt lgkmcnt(8)
    v_pk_add_f32 v[64:65], v[64:65], v[128:129]
    v_pk_add_f32 v[66:67], v[66:67], v[130:131]
    v_pk_add_f32 v[68:69], v[68:69], v[132:133]
    v_pk_add_f32 v[70:71], v[70:71], v[134:135]
    v_pk_add_f32 v[72:73], v[72:73], v[136:137]
    v_pk_add_f32 v[74:75], v[74:75], v[138:139]
    v_pk_add_f32 v[76:77], v[76:77], v[140:141]
    v_pk_add_f32 v[78:79], v[78:79], v[142:143]
    s_waitcnt lgkmcnt(0)
    v_pk_add_f32 v[144:145], v[144:145], v[160:161]
    v_pk_add_f32 v[146:147], v[146:147], v[162:163]
    v_pk_add_f32 v[148:149], v[148:149], v[164:165]
    v_pk_add_f32 v[150:151], v[150:151], v[166:167]
    v_pk_add_f32 v[152:153], v[152:153], v[168:169]
    v_pk_add_f32 v[154:155], v[154:155], v[170:171]
    v_pk_add_f32 v[156:157], v[156:157], v[172:173]
    v_pk_add_f32 v[158:159], v[158:159], v[174:175]
    v_pk_add_f32 v[64:65], v[64:65], v[144:145]
    v_pk_add_f32 v[66:67], v[66:67], v[146:147]
    v_pk_add_f32 v[68:69], v[68:69], v[148:149]
    v_pk_add_f32 v[70:71], v[70:71], v[150:151]
    v_pk_add_f32 v[72:73], v[72:73], v[152:153]
    v_pk_add_f32 v[74:75], v[74:75], v[154:155]
    v_pk_add_f32 v[76:77], v[76:77], v[156:157]
    v_pk_add_f32 v[78:79], v[78:79], v[158:159]
    v_cvt_pk_bf16_f32 v192, v64, v65
    v_cvt_pk_bf16_f32 v193, v66, v67
    v_cvt_pk_bf16_f32 v194, v68, v69
    v_cvt_pk_bf16_f32 v195, v70, v71
    v_cvt_pk_bf16_f32 v196, v72, v73
    v_cvt_pk_bf16_f32 v197, v74, v75
    v_cvt_pk_bf16_f32 v198, v76, v77
    v_cvt_pk_bf16_f32 v199, v78, v79
    v_permlane32_swap_b32 v192, v194
    v_permlane32_swap_b32 v193, v195
    v_permlane32_swap_b32 v196, v198
    v_permlane32_swap_b32 v197, v199
    v_lshlrev_b32 v64, 16, v192
    v_and_b32 v65, 0xffff0000, v192
    v_lshlrev_b32 v66, 16, v193
    v_and_b32 v67, 0xffff0000, v193
    v_lshlrev_b32 v68, 16, v194
    v_and_b32 v69, 0xffff0000, v194
    v_lshlrev_b32 v70, 16, v195
    v_and_b32 v71, 0xffff0000, v195
    v_lshlrev_b32 v72, 16, v196
    v_and_b32 v73, 0xffff0000, v196
    v_lshlrev_b32 v74, 16, v197
    v_and_b32 v75, 0xffff0000, v197
    v_lshlrev_b32 v76, 16, v198
    v_and_b32 v77, 0xffff0000, v198
    v_lshlrev_b32 v78, 16, v199
    v_and_b32 v79, 0xffff0000, v199
    v_pk_add_f32 v[64:65], v[64:65], v[176:177]
    v_pk_add_f32 v[66:67], v[66:67], v[178:179]
    v_pk_add_f32 v[68:69], v[68:69], v[180:181]
    v_pk_add_f32 v[70:71], v[70:71], v[182:183]
    v_pk_add_f32 v[72:73], v[72:73], v[184:185]
    v_pk_add_f32 v[74:75], v[74:75], v[186:187]
    v_pk_add_f32 v[76:77], v[76:77], v[188:189]
    v_pk_add_f32 v[78:79], v[78:79], v[190:191]
    v_cvt_pk_bf16_f32 v192, v64, v65
    v_cvt_pk_bf16_f32 v193, v66, v67
    v_cvt_pk_bf16_f32 v194, v68, v69
    v_cvt_pk_bf16_f32 v195, v70, v71
    v_cvt_pk_bf16_f32 v196, v72, v73
    v_cvt_pk_bf16_f32 v197, v74, v75
    v_cvt_pk_bf16_f32 v198, v76, v77
    v_cvt_pk_bf16_f32 v199, v78, v79
    v_lshlrev_b32 v64, 16, v192
    v_and_b32 v65, 0xffff0000, v192
    v_lshlrev_b32 v66, 16, v193
    v_and_b32 v67, 0xffff0000, v193
    v_lshlrev_b32 v68, 16, v194
    v_and_b32 v69, 0xffff0000, v194
    v_lshlrev_b32 v70, 16, v195
    v_and_b32 v71, 0xffff0000, v195
    v_lshlrev_b32 v72, 16, v196
    v_and_b32 v73, 0xffff0000, v196
    v_lshlrev_b32 v74, 16, v197
    v_and_b32 v75, 0xffff0000, v197
    v_lshlrev_b32 v76, 16, v198
    v_and_b32 v77, 0xffff0000, v198
    v_lshlrev_b32 v78, 16, v199
    v_and_b32 v79, 0xffff0000, v199
    v_lshrrev_b32 v160, 2, v0
    s_lshr_b32 s60, s3, 1
    s_lshl_b32 s60, s60, 5
    v_add_u32 v160, s60, v160
    v_and_b32 v161, 3, v0
    s_and_b32 s61, s3, 1
    s_lshl_b32 s61, s61, 2
    v_add_u32 v161, s61, v161
    v_lshlrev_b32 v162, 10, v160
    v_lshl_add_u32 v162, v161, 4, v162
    v_and_b32 v163, 7, v160
    v_xor_b32 v161, v161, v163
    v_lshlrev_b32 v161, 4, v161
    v_lshl_add_u32 v161, v160, 7, v161
    v_add_u32 v161, 142976, v161
    v_pk_add_f32 v[64:65], v[64:65], v[208:209]
    v_pk_add_f32 v[66:67], v[66:67], v[210:211]
    v_pk_add_f32 v[68:69], v[68:69], v[212:213]
    v_pk_add_f32 v[70:71], v[70:71], v[214:215]
    v_cvt_pk_bf16_f32 v192, v64, v65
    v_cvt_pk_bf16_f32 v193, v66, v67
    v_cvt_pk_bf16_f32 v194, v68, v69
    v_cvt_pk_bf16_f32 v195, v70, v71
    ds_write_b128 v14, v[192:195]
    v_pk_add_f32 v[72:73], v[72:73], v[216:217]
    v_pk_add_f32 v[74:75], v[74:75], v[218:219]
    v_pk_add_f32 v[76:77], v[76:77], v[220:221]
    v_pk_add_f32 v[78:79], v[78:79], v[222:223]
    v_cvt_pk_bf16_f32 v196, v72, v73
    v_cvt_pk_bf16_f32 v197, v74, v75
    v_cvt_pk_bf16_f32 v198, v76, v77
    v_cvt_pk_bf16_f32 v199, v78, v79
    ds_write_b128 v11, v[196:199]
    s_add_u32 s61, s62, 16384
    s_waitcnt lgkmcnt(0)
    ds_read_b128 v[128:131], v161
    ds_read_b128 v[132:135], v161 offset:2048
    s_waitcnt lgkmcnt(1)
    buffer_store_dwordx4 v[128:131], v162, s[36:39], s62 offen sc1
    s_waitcnt lgkmcnt(0)
    buffer_store_dwordx4 v[132:135], v162, s[36:39], s61 offen sc1
    s_endpgm
Lgs_1003:
    s_mov_b32 s94, 65536
Lgl_1005:
    ds_read_b32 v11, v9 offset:0
    s_waitcnt lgkmcnt(0)
    v_cmp_gt_u32 vcc, 8, v11
    s_cbranch_vccz Lgb_1004
    s_sub_u32 s94, s94, 1
    s_cbranch_scc0 Lgl_1005
    s_branch Lgb_1004
Lgs_1006:
    s_mov_b32 s94, 65536
Lgl_1008:
    ds_read_b32 v11, v9 offset:0
    s_waitcnt lgkmcnt(0)
    v_cmp_gt_u32 vcc, 12, v11
    s_cbranch_vccz Lgb_1007
    s_sub_u32 s94, s94, 1
    s_cbranch_scc0 Lgl_1008
    s_branch Lgb_1007
Lgs_1009:
    s_mov_b32 s94, 65536
Lgl_1011:
    ds_read_b32 v11, v9 offset:0
    s_waitcnt lgkmcnt(0)
    v_cmp_gt_u32 vcc, 16, v11
    s_cbranch_vccz Lgb_1010
    s_sub_u32 s94, s94, 1
    s_cbranch_scc0 Lgl_1011
    s_branch Lgb_1010
Lgs_1012:
    s_mov_b32 s94, 65536
Lgl_1014:
    ds_read_b32 v11, v9 offset:0
    s_waitcnt lgkmcnt(0)
    v_cmp_gt_u32 vcc, 20, v11
    s_cbranch_vccz Lgb_1013
    s_sub_u32 s94, s94, 1
    s_cbranch_scc0 Lgl_1014
    s_branch Lgb_1013
Lgs_1015:
    s_mov_b32 s94, 65536
Lgl_1017:
    ds_read_b32 v11, v9 offset:0
    s_waitcnt lgkmcnt(0)
    v_cmp_gt_u32 vcc, 24, v11
    s_cbranch_vccz Lgb_1016
    s_sub_u32 s94, s94, 1
    s_cbranch_scc0 Lgl_1017
    s_branch Lgb_1016
Lgs_1018:
    s_mov_b32 s94, 65536
Lgl_1020:
    ds_read_b32 v11, v9 offset:0
    s_waitcnt lgkmcnt(0)
    v_cmp_gt_u32 vcc, 28, v11
    s_cbranch_vccz Lgb_1019
    s_sub_u32 s94, s94, 1
    s_cbranch_scc0 Lgl_1020
    s_branch Lgb_1019
Lgs_1021:
    s_mov_b32 s94, 65536
Lgl_1023:
    ds_read_b32 v11, v9 offset:0
    s_waitcnt lgkmcnt(0)
    v_cmp_gt_u32 vcc, 32, v11
    s_cbranch_vccz Lgb_1022
    s_sub_u32 s94, s94, 1
    s_cbranch_scc0 Lgl_1023
    s_branch Lgb_1022
Lgr_1024:
    s_mov_b32 s94, 65536
Lgrl_1026:
    buffer_load_dwordx4 v[36:39], v1, s[44:47], s93 offen sc1
    buffer_load_dwordx4 v[40:43], v60, s[44:47], s92 offen sc1
    buffer_load_dwordx4 v[44:47], v60, s[44:47], s92 offen offset:512 sc1
    s_waitcnt vmcnt(0)
    v_cmp_ne_u32 vcc, s35, v39
    v_cmp_ne_u32 s[60:61], s35, v43
    s_or_b64 vcc, vcc, s[60:61]
    v_cmp_ne_u32 s[60:61], s35, v47
    s_or_b64 vcc, vcc, s[60:61]
    s_cbranch_vccz Lgrb_1025
    s_sub_u32 s94, s94, 1
    s_cbranch_scc0 Lgrl_1026
    s_branch Lgrb_1025
Lgs_1027:
    s_mov_b32 s94, 65536
Lgl_1029:
    ds_read_b32 v11, v9 offset:0
    s_waitcnt lgkmcnt(0)
    v_cmp_gt_u32 vcc, 36, v11
    s_cbranch_vccz Lgb_1028
    s_sub_u32 s94, s94, 1
    s_cbranch_scc0 Lgl_1029
    s_branch Lgb_1028
Lhs_1030:
    s_waitcnt vmcnt(1)
    buffer_store_dword v12, off, s[44:47], s100 offset:96 sc1
    s_mov_b32 s94, 65536
Lhl_1032:
    s_load_dwordx8 s[36:43], s[32:33], s101 offset:0 glc
    s_waitcnt lgkmcnt(0)
    s_xor_b64 s[36:37], s[36:37], s[62:63]
    s_xor_b64 s[38:39], s[38:39], s[62:63]
    s_xor_b64 s[40:41], s[40:41], s[62:63]
    s_xor_b32 s42, s42, s62
    s_or_b64 s[36:37], s[36:37], s[38:39]
    s_or_b32 s40, s40, s42
    s_or_b64 s[36:37], s[36:37], s[40:41]
    s_cbranch_scc0 Lhb_1031
    s_sub_u32 s94, s94, 1
    s_cbranch_scc0 Lhl_1032
    s_branch Lhb_1031
Lhs_1033:
    s_waitcnt vmcnt(15)
    buffer_store_dword v12, off, s[44:47], s100 offset:96 sc1
    s_mov_b32 s94, 65536
Lhl_1035:
    s_load_dwordx8 s[20:27], s[32:33], s101 offset:32 glc
    s_waitcnt lgkmcnt(0)
    s_xor_b64 s[20:21], s[20:21], s[62:63]
    s_xor_b64 s[22:23], s[22:23], s[62:63]
    s_xor_b64 s[24:25], s[24:25], s[62:63]
    s_xor_b32 s26, s26, s62
    s_or_b64 s[20:21], s[20:21], s[22:23]
    s_or_b32 s24, s24, s26
    s_or_b64 s[20:21], s[20:21], s[24:25]
    s_cbranch_scc0 Lhb_1034
    s_sub_u32 s94, s94, 1
    s_cbranch_scc0 Lhl_1035
    s_branch Lhb_1034
Lhs_1036:
    s_mov_b32 s94, 65536
Lhl_1038:
    s_load_dwordx8 s[36:43], s[32:33], s101 offset:64 glc
    s_waitcnt lgkmcnt(0)
    s_xor_b64 s[36:37], s[36:37], s[62:63]
    s_xor_b64 s[38:39], s[38:39], s[62:63]
    s_xor_b64 s[40:41], s[40:41], s[62:63]
    s_xor_b32 s42, s42, s62
    s_or_b64 s[36:37], s[36:37], s[38:39]
    s_or_b32 s40, s40, s42
    s_or_b64 s[36:37], s[36:37], s[40:41]
    s_cbranch_scc0 Lhb_1037
    s_sub_u32 s94, s94, 1
    s_cbranch_scc0 Lhl_1038
    s_branch Lhb_1037
Lhs_1039:
    s_mov_b32 s94, 65536
Lhl_1041:
    s_load_dwordx8 s[20:27], s[32:33], s101 offset:96 glc
    s_waitcnt lgkmcnt(0)
    s_xor_b64 s[20:21], s[20:21], s[62:63]
    s_xor_b64 s[22:23], s[22:23], s[62:63]
    s_xor_b64 s[24:25], s[24:25], s[62:63]
    s_xor_b32 s26, s26, s62
    s_or_b64 s[20:21], s[20:21], s[22:23]
    s_or_b32 s24, s24, s26
    s_or_b64 s[20:21], s[20:21], s[24:25]
    s_cbranch_scc0 Lhb_1040
    s_sub_u32 s94, s94, 1
    s_cbranch_scc0 Lhl_1041
    s_branch Lhb_1040
Laux:
    v_lshrrev_b32 v56, 3, v0
    s_lshl_b32 s60, s3, 7
    v_add_u32 v56, s60, v56
    s_movk_i32 s61, 3584
    v_mul_lo_u32 v56, v56, s61
    v_and_b32 v57, 7, v0
    v_lshl_add_u32 v16, v57, 4, v56
    s_sub_u32 s92, s2, 224
    s_lshl_b32 s60, s92, 7
    v_lshlrev_b32 v17, 1, v0
    v_add_u32 v17, s60, v17
    s_waitcnt lgkmcnt(0)
    s_mov_b32 s40, s20
    s_mov_b32 s41, s21
    s_mov_b32 s42, 1835008
    s_mov_b32 s43, 0x20000
    s_load_dword s34, s[32:33], 0
    s_cmp_ge_u32 s92, 28
    s_cbranch_scc1 Lauxno_1045
    buffer_load_dwordx4 v[64:67], v16, s[40:43], s60 offen
    s_add_u32 s60, s60, 28672
    buffer_load_dwordx4 v[68:71], v16, s[40:43], s60 offen
    s_add_u32 s60, s60, 28672
    buffer_load_dwordx4 v[72:75], v16, s[40:43], s60 offen
    s_add_u32 s60, s60, 28672
    buffer_load_dwordx4 v[76:79], v16, s[40:43], s60 offen
    s_add_u32 s60, s60, 28672
    buffer_load_dwordx4 v[80:83], v16, s[40:43], s60 offen
    s_add_u32 s60, s60, 28672
    buffer_load_dwordx4 v[84:87], v16, s[40:43], s60 offen
    s_add_u32 s60, s60, 28672
    buffer_load_dwordx4 v[88:91], v16, s[40:43], s60 offen
    s_add_u32 s60, s60, 28672
    buffer_load_dwordx4 v[92:95], v16, s[40:43], s60 offen
    s_add_u32 s60, s60, 28672
    buffer_load_dwordx4 v[96:99], v16, s[40:43], s60 offen
    s_add_u32 s60, s60, 28672
    buffer_load_dwordx4 v[100:103], v16, s[40:43], s60 offen
    s_add_u32 s60, s60, 28672
    buffer_load_dwordx4 v[104:107], v16, s[40:43], s60 offen
    s_add_u32 s60, s60, 28672
    buffer_load_dwordx4 v[108:111], v16, s[40:43], s60 offen
    s_add_u32 s60, s60, 28672
    buffer_load_dwordx4 v[112:115], v16, s[40:43], s60 offen
    s_add_u32 s60, s60, 28672
    buffer_load_dwordx4 v[116:119], v16, s[40:43], s60 offen
    s_add_u32 s60, s60, 28672
    buffer_load_dwordx4 v[120:123], v16, s[40:43], s60 offen
    s_add_u32 s60, s60, 28672
    buffer_load_dwordx4 v[124:127], v16, s[40:43], s60 offen
    s_add_u32 s60, s60, 28672
    global_load_ushort v18, v17, s[22:23]
Lauxno_1045:
    s_mov_b32 s44, s32
    s_mov_b32 s45, s33
    s_mov_b32 s46, 20971520
    s_mov_b32 s47, 0x20000
    s_lshr_b32 s60, s59, 3
    s_lshl_b32 s56, s58, 2
    s_add_u32 s56, s56, s60
    s_add_u32 s57, s59, 0
    s_and_b32 s57, s57, 7
    s_lshl_b32 s98, s3, 13
    s_lshl_b32 s60, s56, 2
    s_add_u32 s60, s60, s3
    s_lshl_b32 s60, s60, 7
    s_add_u32 s101, s60, 65536
    s_mov_b32 s48, s24
    s_mov_b32 s49, s25
    s_mov_b32 s50, 1835008
    s_mov_b32 s51, 0x20000
    s_mul_i32 s61, s3, 7
    s_mul_i32 s62, s56, 224
    s_add_u32 s62, s62, s61
    s_mul_i32 s61, s3, 28
    s_lshl_b32 s62, s62, 10
    s_add_u32 s62, s62, 10485760
    s_lshl_b32 s61, s61, 14
    s_lshl_b32 s60, s57, 7
    s_add_u32 s61, s61, s60
    s_lshr_b32 s95, s59, 3
    s_lshl_b32 s95, s95, 31
    s_and_b32 s95, s95, 7
    s_add_u32 s60, s57, s95
    s_mul_i32 s95, s60, 37
    s_lshr_b32 s95, s95, 8
    s_mul_i32 s95, s95, 7
    s_sub_u32 s60, s60, s95
    s_lshl_b32 s95, s60, 10
    s_add_u32 s4, s62, s95
    s_lshl_b32 s95, s60, 16
    s_add_u32 s11, s61, s95
    s_add_u32 s60, s60, 1
    s_cmp_eq_u32 s60, 7
    s_cselect_b32 s60, 0, s60
    s_lshl_b32 s95, s60, 10
    s_add_u32 s5, s62, s95
    s_lshl_b32 s95, s60, 16
    s_add_u32 s12, s61, s95
    s_add_u32 s60, s60, 1
    s_cmp_eq_u32 s60, 7
    s_cselect_b32 s60, 0, s60
    s_lshl_b32 s95, s60, 10
    s_add_u32 s6, s62, s95
    s_lshl_b32 s95, s60, 16
    s_add_u32 s13, s61, s95
    s_add_u32 s60, s60, 1
    s_cmp_eq_u32 s60, 7
    s_cselect_b32 s60, 0, s60
    s_lshl_b32 s95, s60, 10
    s_add_u32 s7, s62, s95
    s_lshl_b32 s95, s60, 16
    s_add_u32 s14, s61, s95
    s_add_u32 s60, s60, 1
    s_cmp_eq_u32 s60, 7
    s_cselect_b32 s60, 0, s60
    s_lshl_b32 s95, s60, 10
    s_add_u32 s8, s62, s95
    s_lshl_b32 s95, s60, 16
    s_add_u32 s15, s61, s95
    s_add_u32 s60, s60, 1
    s_cmp_eq_u32 s60, 7
    s_cselect_b32 s60, 0, s60
    s_lshl_b32 s95, s60, 10
    s_add_u32 s9, s62, s95
    s_lshl_b32 s95, s60, 16
    s_add_u32 s16, s61, s95
    s_add_u32 s60, s60, 1
    s_cmp_eq_u32 s60, 7
    s_cselect_b32 s60, 0, s60
    s_lshl_b32 s95, s60, 10
    s_add_u32 s10, s62, s95
    s_lshl_b32 s95, s60, 16
    s_add_u32 s17, s61, s95
    v_lshlrev_b32 v1, 4, v0
    v_add_u32 v2, 114688, v1
    s_lshr_b32 s60, s3, 1
    s_mul_i32 s60, s60, 114688
    v_add_u32 v14, s60, v1
    s_sub_u32 s60, 114688, s60
    v_add_u32 v15, s60, v1
    v_and_b32 v13, 31, v0
    v_lshlrev_b32 v13, 2, v13
    v_lshrrev_b32 v56, 3, v0
    v_and_b32 v57, 7, v0
    v_bfe_u32 v58, v0, 4, 1
    v_lshlrev_b32 v59, 2, v58
    v_xor_b32 v59, v59, v57
    v_lshlrev_b32 v3, 10, v56
    v_lshl_add_u32 v3, v59, 4, v3
    v_add_u32 v4, 7168, v3
    v_lshrrev_b32 v56, 5, v0
    v_bfe_u32 v57, v0, 2, 2
    v_lshl_add_u32 v56, v56, 2, v57
    v_bfe_u32 v57, v0, 3, 1
    v_lshlrev_b32 v57, 2, v57
    v_lshl_add_u32 v57, v58, 1, v57
    v_bfe_u32 v58, v0, 1, 1
    v_add_u32 v57, v57, v58
    v_lshlrev_b32 v56, 7, v56
    v_lshl_add_u32 v56, v57, 4, v56
    v_and_b32 v58, 1, v0
    v_lshl_add_u32 v56, v58, 3, v56
    s_and_b32 s60, s3, 1
    s_lshl_b32 s60, s60, 6
    v_xor_b32 v56, s60, v56
    v_add_u32 v5, s98, v56
    v_xor_b32 v6, 64, v5
    v_add_u32 v7, 0x10000, v5
    v_add_u32 v8, 0x10000, v6
    v_mov_b32 v9, 152064
    v_mov_b32 v10, 1
    s_waitcnt lgkmcnt(0)
    s_add_u32 s35, s34, 0x9E3779B9
    v_mov_b32 v12, s35
    s_barrier
    s_cmp_ge_u32 s92, 28
    s_cbranch_scc1 Lauxst_1044
    s_waitcnt vmcnt(16)
    v_lshlrev_b32 v20, 16, v64
    v_and_b32 v21, 0xffff0000, v64
    v_lshlrev_b32 v22, 16, v65
    v_and_b32 v23, 0xffff0000, v65
    v_lshlrev_b32 v24, 16, v66
    v_and_b32 v25, 0xffff0000, v66
    v_lshlrev_b32 v26, 16, v67
    v_and_b32 v27, 0xffff0000, v67
    s_waitcnt vmcnt(15)
    v_lshlrev_b32 v28, 16, v68
    v_and_b32 v29, 0xffff0000, v68
    v_lshlrev_b32 v30, 16, v69
    v_and_b32 v31, 0xffff0000, v69
    v_lshlrev_b32 v32, 16, v70
    v_and_b32 v33, 0xffff0000, v70
    v_lshlrev_b32 v34, 16, v71
    v_and_b32 v35, 0xffff0000, v71
    v_add_f32 v20, v20, v28
    v_add_f32 v21, v21, v29
    v_add_f32 v22, v22, v30
    v_add_f32 v23, v23, v31
    v_add_f32 v24, v24, v32
    v_add_f32 v25, v25, v33
    v_add_f32 v26, v26, v34
    v_add_f32 v27, v27, v35
    s_waitcnt vmcnt(14)
    v_lshlrev_b32 v28, 16, v72
    v_and_b32 v29, 0xffff0000, v72
    v_lshlrev_b32 v30, 16, v73
    v_and_b32 v31, 0xffff0000, v73
    v_lshlrev_b32 v32, 16, v74
    v_and_b32 v33, 0xffff0000, v74
    v_lshlrev_b32 v34, 16, v75
    v_and_b32 v35, 0xffff0000, v75
    v_add_f32 v20, v20, v28
    v_add_f32 v21, v21, v29
    v_add_f32 v22, v22, v30
    v_add_f32 v23, v23, v31
    v_add_f32 v24, v24, v32
    v_add_f32 v25, v25, v33
    v_add_f32 v26, v26, v34
    v_add_f32 v27, v27, v35
    s_waitcnt vmcnt(13)
    v_lshlrev_b32 v28, 16, v76
    v_and_b32 v29, 0xffff0000, v76
    v_lshlrev_b32 v30, 16, v77
    v_and_b32 v31, 0xffff0000, v77
    v_lshlrev_b32 v32, 16, v78
    v_and_b32 v33, 0xffff0000, v78
    v_lshlrev_b32 v34, 16, v79
    v_and_b32 v35, 0xffff0000, v79
    v_add_f32 v20, v20, v28
    v_add_f32 v21, v21, v29
    v_add_f32 v22, v22, v30
    v_add_f32 v23, v23, v31
    v_add_f32 v24, v24, v32
    v_add_f32 v25, v25, v33
    v_add_f32 v26, v26, v34
    v_add_f32 v27, v27, v35
    s_waitcnt vmcnt(12)
    v_lshlrev_b32 v28, 16, v80
    v_and_b32 v29, 0xffff0000, v80
    v_lshlrev_b32 v30, 16, v81
    v_and_b32 v31, 0xffff0000, v81
    v_lshlrev_b32 v32, 16, v82
    v_and_b32 v33, 0xffff0000, v82
    v_lshlrev_b32 v34, 16, v83
    v_and_b32 v35, 0xffff0000, v83
    v_add_f32 v20, v20, v28
    v_add_f32 v21, v21, v29
    v_add_f32 v22, v22, v30
    v_add_f32 v23, v23, v31
    v_add_f32 v24, v24, v32
    v_add_f32 v25, v25, v33
    v_add_f32 v26, v26, v34
    v_add_f32 v27, v27, v35
    s_waitcnt vmcnt(11)
    v_lshlrev_b32 v28, 16, v84
    v_and_b32 v29, 0xffff0000, v84
    v_lshlrev_b32 v30, 16, v85
    v_and_b32 v31, 0xffff0000, v85
    v_lshlrev_b32 v32, 16, v86
    v_and_b32 v33, 0xffff0000, v86
    v_lshlrev_b32 v34, 16, v87
    v_and_b32 v35, 0xffff0000, v87
    v_add_f32 v20, v20, v28
    v_add_f32 v21, v21, v29
    v_add_f32 v22, v22, v30
    v_add_f32 v23, v23, v31
    v_add_f32 v24, v24, v32
    v_add_f32 v25, v25, v33
    v_add_f32 v26, v26, v34
    v_add_f32 v27, v27, v35
    s_waitcnt vmcnt(10)
    v_lshlrev_b32 v28, 16, v88
    v_and_b32 v29, 0xffff0000, v88
    v_lshlrev_b32 v30, 16, v89
    v_and_b32 v31, 0xffff0000, v89
    v_lshlrev_b32 v32, 16, v90
    v_and_b32 v33, 0xffff0000, v90
    v_lshlrev_b32 v34, 16, v91
    v_and_b32 v35, 0xffff0000, v91
    v_add_f32 v20, v20, v28
    v_add_f32 v21, v21, v29
    v_add_f32 v22, v22, v30
    v_add_f32 v23, v23, v31
    v_add_f32 v24, v24, v32
    v_add_f32 v25, v25, v33
    v_add_f32 v26, v26, v34
    v_add_f32 v27, v27, v35
    s_waitcnt vmcnt(9)
    v_lshlrev_b32 v28, 16, v92
    v_and_b32 v29, 0xffff0000, v92
    v_lshlrev_b32 v30, 16, v93
    v_and_b32 v31, 0xffff0000, v93
    v_lshlrev_b32 v32, 16, v94
    v_and_b32 v33, 0xffff0000, v94
    v_lshlrev_b32 v34, 16, v95
    v_and_b32 v35, 0xffff0000, v95
    v_add_f32 v20, v20, v28
    v_add_f32 v21, v21, v29
    v_add_f32 v22, v22, v30
    v_add_f32 v23, v23, v31
    v_add_f32 v24, v24, v32
    v_add_f32 v25, v25, v33
    v_add_f32 v26, v26, v34
    v_add_f32 v27, v27, v35
    s_waitcnt vmcnt(8)
    v_lshlrev_b32 v28, 16, v96
    v_and_b32 v29, 0xffff0000, v96
    v_lshlrev_b32 v30, 16, v97
    v_and_b32 v31, 0xffff0000, v97
    v_lshlrev_b32 v32, 16, v98
    v_and_b32 v33, 0xffff0000, v98
    v_lshlrev_b32 v34, 16, v99
    v_and_b32 v35, 0xffff0000, v99
    v_add_f32 v20, v20, v28
    v_add_f32 v21, v21, v29
    v_add_f32 v22, v22, v30
    v_add_f32 v23, v23, v31
    v_add_f32 v24, v24, v32
    v_add_f32 v25, v25, v33
    v_add_f32 v26, v26, v34
    v_add_f32 v27, v27, v35
    s_waitcnt vmcnt(7)
    v_lshlrev_b32 v28, 16, v100
    v_and_b32 v29, 0xffff0000, v100
    v_lshlrev_b32 v30, 16, v101
    v_and_b32 v31, 0xffff0000, v101
    v_lshlrev_b32 v32, 16, v102
    v_and_b32 v33, 0xffff0000, v102
    v_lshlrev_b32 v34, 16, v103
    v_and_b32 v35, 0xffff0000, v103
    v_add_f32 v20, v20, v28
    v_add_f32 v21, v21, v29
    v_add_f32 v22, v22, v30
    v_add_f32 v23, v23, v31
    v_add_f32 v24, v24, v32
    v_add_f32 v25, v25, v33
    v_add_f32 v26, v26, v34
    v_add_f32 v27, v27, v35
    s_waitcnt vmcnt(6)
    v_lshlrev_b32 v28, 16, v104
    v_and_b32 v29, 0xffff0000, v104
    v_lshlrev_b32 v30, 16, v105
    v_and_b32 v31, 0xffff0000, v105
    v_lshlrev_b32 v32, 16, v106
    v_and_b32 v33, 0xffff0000, v106
    v_lshlrev_b32 v34, 16, v107
    v_and_b32 v35, 0xffff0000, v107
    v_add_f32 v20, v20, v28
    v_add_f32 v21, v21, v29
    v_add_f32 v22, v22, v30
    v_add_f32 v23, v23, v31
    v_add_f32 v24, v24, v32
    v_add_f32 v25, v25, v33
    v_add_f32 v26, v26, v34
    v_add_f32 v27, v27, v35
    s_waitcnt vmcnt(5)
    v_lshlrev_b32 v28, 16, v108
    v_and_b32 v29, 0xffff0000, v108
    v_lshlrev_b32 v30, 16, v109
    v_and_b32 v31, 0xffff0000, v109
    v_lshlrev_b32 v32, 16, v110
    v_and_b32 v33, 0xffff0000, v110
    v_lshlrev_b32 v34, 16, v111
    v_and_b32 v35, 0xffff0000, v111
    v_add_f32 v20, v20, v28
    v_add_f32 v21, v21, v29
    v_add_f32 v22, v22, v30
    v_add_f32 v23, v23, v31
    v_add_f32 v24, v24, v32
    v_add_f32 v25, v25, v33
    v_add_f32 v26, v26, v34
    v_add_f32 v27, v27, v35
    s_waitcnt vmcnt(4)
    v_lshlrev_b32 v28, 16, v112
    v_and_b32 v29, 0xffff0000, v112
    v_lshlrev_b32 v30, 16, v113
    v_and_b32 v31, 0xffff0000, v113
    v_lshlrev_b32 v32, 16, v114
    v_and_b32 v33, 0xffff0000, v114
    v_lshlrev_b32 v34, 16, v115
    v_and_b32 v35, 0xffff0000, v115
    v_add_f32 v20, v20, v28
    v_add_f32 v21, v21, v29
    v_add_f32 v22, v22, v30
    v_add_f32 v23, v23, v31
    v_add_f32 v24, v24, v32
    v_add_f32 v25, v25, v33
    v_add_f32 v26, v26, v34
    v_add_f32 v27, v27, v35
    s_waitcnt vmcnt(3)
    v_lshlrev_b32 v28, 16, v116
    v_and_b32 v29, 0xffff0000, v116
    v_lshlrev_b32 v30, 16, v117
    v_and_b32 v31, 0xffff0000, v117
    v_lshlrev_b32 v32, 16, v118
    v_and_b32 v33, 0xffff0000, v118
    v_lshlrev_b32 v34, 16, v119
    v_and_b32 v35, 0xffff0000, v119
    v_add_f32 v20, v20, v28
    v_add_f32 v21, v21, v29
    v_add_f32 v22, v22, v30
    v_add_f32 v23, v23, v31
    v_add_f32 v24, v24, v32
    v_add_f32 v25, v25, v33
    v_add_f32 v26, v26, v34
    v_add_f32 v27, v27, v35
    s_waitcnt vmcnt(2)
    v_lshlrev_b32 v28, 16, v120
    v_and_b32 v29, 0xffff0000, v120
    v_lshlrev_b32 v30, 16, v121
    v_and_b32 v31, 0xffff0000, v121
    v_lshlrev_b32 v32, 16, v122
    v_and_b32 v33, 0xffff0000, v122
    v_lshlrev_b32 v34, 16, v123
    v_and_b32 v35, 0xffff0000, v123
    v_add_f32 v20, v20, v28
    v_add_f32 v21, v21, v29
    v_add_f32 v22, v22, v30
    v_add_f32 v23, v23, v31
    v_add_f32 v24, v24, v32
    v_add_f32 v25, v25, v33
    v_add_f32 v26, v26, v34
    v_add_f32 v27, v27, v35
    s_waitcnt vmcnt(1)
    v_lshlrev_b32 v28, 16, v124
    v_and_b32 v29, 0xffff0000, v124
    v_lshlrev_b32 v30, 16, v125
    v_and_b32 v31, 0xffff0000, v125
    v_lshlrev_b32 v32, 16, v126
    v_and_b32 v33, 0xffff0000, v126
    v_lshlrev_b32 v34, 16, v127
    v_and_b32 v35, 0xffff0000, v127
    v_add_f32 v20, v20, v28
    v_add_f32 v21, v21, v29
    v_add_f32 v22, v22, v30
    v_add_f32 v23, v23, v31
    v_add_f32 v24, v24, v32
    v_add_f32 v25, v25, v33
    v_add_f32 v26, v26, v34
    v_add_f32 v27, v27, v35
    v_add_f32_dpp v20, v20, v20 row_ror:8 row_mask:0xf bank_mask:0xf
    v_add_f32_dpp v21, v21, v21 row_ror:8 row_mask:0xf bank_mask:0xf
    v_add_f32_dpp v22, v22, v22 row_ror:8 row_mask:0xf bank_mask:0xf
    v_add_f32_dpp v23, v23, v23 row_ror:8 row_mask:0xf bank_mask:0xf
    v_add_f32_dpp v24, v24, v24 row_ror:8 row_mask:0xf bank_mask:0xf
    v_add_f32_dpp v25, v25, v25 row_ror:8 row_mask:0xf bank_mask:0xf
    v_add_f32_dpp v26, v26, v26 row_ror:8 row_mask:0xf bank_mask:0xf
    v_add_f32_dpp v27, v27, v27 row_ror:8 row_mask:0xf bank_mask:0xf
    v_permlane16_swap_b32 v20, v24
    v_permlane16_swap_b32 v21, v25
    v_permlane16_swap_b32 v22, v26
    v_permlane16_swap_b32 v23, v27
    v_add_f32 v20, v20, v24
    v_add_f32 v21, v21, v25
    v_add_f32 v22, v22, v26
    v_add_f32 v23, v23, v27
    s_nop 0
    v_permlane32_swap_b32 v20, v22
    v_permlane32_swap_b32 v21, v23
    v_add_f32 v20, v20, v22
    v_add_f32 v21, v21, v23
    v_and_b32 v56, 7, v0
    v_lshlrev_b32 v56, 5, v56
    v_lshrrev_b32 v57, 5, v0
    v_lshl_add_u32 v56, v57, 3, v56
    v_bfe_u32 v57, v0, 4, 1
    v_lshl_add_u32 v56, v57, 4, v56
    s_lshl_b32 s60, s3, 8
    s_add_u32 s60, s60, 152192
    v_add_u32 v56, s60, v56
    ds_write_b64 v56, v[20:21]
    s_waitcnt lgkmcnt(0)
    s_mov_b64 exec, 1
    ds_add_u32 v9, v10 offset:0
    s_mov_b64 exec, -1
    s_cmp_lg_u32 s3, 0
    s_cbranch_scc1 Lauxst_1044
    s_mov_b32 s94, 65536
Lw_1046:
    ds_read_b32 v11, v9 offset:0
    s_waitcnt lgkmcnt(0)
    v_cmp_gt_u32 vcc, 4, v11
    s_cbranch_vccz Lwd_1047
    s_sub_u32 s94, s94, 1
    s_cbranch_scc0 Lw_1046
Lwd_1047:
    v_lshlrev_b32 v56, 2, v0
    v_add_u32 v56, 152192, v56
    ds_read_b32 v20, v56
    ds_read_b32 v21, v56 offset:256
    ds_read_b32 v22, v56 offset:512
    ds_read_b32 v23, v56 offset:768
    s_waitcnt vmcnt(0) lgkmcnt(0)
    v_lshlrev_b32 v18, 16, v18
    v_add_f32 v20, v20, v21
    v_add_f32 v22, v22, v23
    v_add_f32 v20, v20, v22
    v_cvt_pk_bf16_f32 v21, v20, v20
    v_and_b32 v21, 0xffff0000, v21
    v_sub_f32 v22, v20, v21
    v_cvt_pk_bf16_f32 v24, v21, v21
    v_cvt_pk_bf16_f32 v25, v22, v18
    v_cvt_pk_bf16_f32 v26, v18, v22
    v_mov_b32 v27, s35
    s_lshl_b32 s60, s92, 10
    s_add_u32 s60, s60, 131072
    buffer_store_dwordx4 v[24:27], v1, s[44:47], s60 offen sc1
Lauxst_1044:
    s_lshl_b32 s60, s92, 2
    s_add_u32 s60, s60, s3
    s_lshl_b32 s60, s60, 7
    s_and_b32 s60, s60, 0x3fff
    s_add_u32 s100, s60, 81920
    v_lshlrev_b32 v16, 7, v0
    s_sub_u32 s95, s59, 28
    s_lshl_b32 s95, s95, 2
    s_add_u32 s95, s95, s3
    s_mul_i32 s60, s95, 1171
    s_lshr_b32 s60, s60, 16
    s_mul_i32 s61, s60, 56
    s_sub_u32 s61, s95, s61
    s_lshl_b32 s60, s60, 14
    s_lshr_b32 s62, s61, 1
    s_lshl_b32 s62, s62, 16
    s_add_u32 s60, s60, s62
    s_and_b32 s61, s61, 1
    s_lshl_b32 s61, s61, 13
    s_add_u32 s60, s60, s61
    s_add_u32 s95, s95, 16
    buffer_load_dword v17, v16, s[48:51], s60 offen
    s_mul_i32 s60, s95, 1171
    s_lshr_b32 s60, s60, 16
    s_mul_i32 s61, s60, 56
    s_sub_u32 s61, s95, s61
    s_lshl_b32 s60, s60, 14
    s_lshr_b32 s62, s61, 1
    s_lshl_b32 s62, s62, 16
    s_add_u32 s60, s60, s62
    s_and_b32 s61, s61, 1
    s_lshl_b32 s61, s61, 13
    s_add_u32 s60, s60, s61
    s_add_u32 s95, s95, 16
    buffer_load_dword v17, v16, s[48:51], s60 offen
    s_waitcnt vmcnt(1)
    s_mul_i32 s60, s95, 1171
    s_lshr_b32 s60, s60, 16
    s_mul_i32 s61, s60, 56
    s_sub_u32 s61, s95, s61
    s_lshl_b32 s60, s60, 14
    s_lshr_b32 s62, s61, 1
    s_lshl_b32 s62, s62, 16
    s_add_u32 s60, s60, s62
    s_and_b32 s61, s61, 1
    s_lshl_b32 s61, s61, 13
    s_add_u32 s60, s60, s61
    s_add_u32 s95, s95, 16
    buffer_load_dword v17, v16, s[48:51], s60 offen
    s_waitcnt vmcnt(1)
    s_mul_i32 s60, s95, 1171
    s_lshr_b32 s60, s60, 16
    s_mul_i32 s61, s60, 56
    s_sub_u32 s61, s95, s61
    s_lshl_b32 s60, s60, 14
    s_lshr_b32 s62, s61, 1
    s_lshl_b32 s62, s62, 16
    s_add_u32 s60, s60, s62
    s_and_b32 s61, s61, 1
    s_lshl_b32 s61, s61, 13
    s_add_u32 s60, s60, s61
    s_add_u32 s95, s95, 16
    buffer_load_dword v17, v16, s[48:51], s60 offen
    s_waitcnt vmcnt(1)
    s_mul_i32 s60, s95, 1171
    s_lshr_b32 s60, s60, 16
    s_mul_i32 s61, s60, 56
    s_sub_u32 s61, s95, s61
    s_lshl_b32 s60, s60, 14
    s_lshr_b32 s62, s61, 1
    s_lshl_b32 s62, s62, 16
    s_add_u32 s60, s60, s62
    s_and_b32 s61, s61, 1
    s_lshl_b32 s61, s61, 13
    s_add_u32 s60, s60, s61
    s_add_u32 s95, s95, 16
    buffer_load_dword v17, v16, s[48:51], s60 offen
    s_waitcnt vmcnt(1)
    s_mul_i32 s60, s95, 1171
    s_lshr_b32 s60, s60, 16
    s_mul_i32 s61, s60, 56
    s_sub_u32 s61, s95, s61
    s_lshl_b32 s60, s60, 14
    s_lshr_b32 s62, s61, 1
    s_lshl_b32 s62, s62, 16
    s_add_u32 s60, s60, s62
    s_and_b32 s61, s61, 1
    s_lshl_b32 s61, s61, 13
    s_add_u32 s60, s60, s61
    s_add_u32 s95, s95, 16
    buffer_load_dword v17, v16, s[48:51], s60 offen
    s_add_u32 m0, s98, 65536
    s_add_u32 s34, s11, 0
    buffer_load_dwordx4 v3, s[48:51], s34 offen lds
    buffer_load_dwordx4 v4, s[48:51], s34 offen offset:1024 lds
    s_add_u32 m0, s98, 67584
    s_add_u32 s34, s12, 0
    buffer_load_dwordx4 v3, s[48:51], s34 offen lds
    buffer_load_dwordx4 v4, s[48:51], s34 offen offset:1024 lds
    s_add_u32 m0, s98, 69632
    s_add_u32 s34, s13, 0
    buffer_load_dwordx4 v3, s[48:51], s34 offen lds
    buffer_load_dwordx4 v4, s[48:51], s34 offen offset:1024 lds
    s_add_u32 m0, s98, 71680
    s_add_u32 s34, s14, 0
    buffer_load_dwordx4 v3, s[48:51], s34 offen lds
    buffer_load_dwordx4 v4, s[48:51], s34 offen offset:1024 lds
    s_add_u32 m0, s98, 0
    s_add_u32 s34, s15, 0
    buffer_load_dwordx4 v3, s[48:51], s34 offen lds
    buffer_load_dwordx4 v4, s[48:51], s34 offen offset:1024 lds
    s_add_u32 m0, s98, 2048
    s_add_u32 s34, s16, 0
    buffer_load_dwordx4 v3, s[48:51], s34 offen lds
    buffer_load_dwordx4 v4, s[48:51], s34 offen offset:1024 lds
    s_add_u32 m0, s98, 4096
    s_add_u32 s34, s17, 0
    buffer_load_dwordx4 v3, s[48:51], s34 offen lds
    buffer_load_dwordx4 v4, s[48:51], s34 offen offset:1024 lds
    s_add_u32 m0, s98, 6144
    s_add_u32 s34, s11, 16384
    buffer_load_dwordx4 v3, s[48:51], s34 offen lds
    buffer_load_dwordx4 v4, s[48:51], s34 offen offset:1024 lds
    s_add_u32 m0, s98, 32768
    s_add_u32 s34, s12, 16384
    buffer_load_dwordx4 v3, s[48:51], s34 offen lds
    buffer_load_dwordx4 v4, s[48:51], s34 offen offset:1024 lds
    s_add_u32 m0, s98, 34816
    s_add_u32 s34, s13, 16384
    buffer_load_dwordx4 v3, s[48:51], s34 offen lds
    buffer_load_dwordx4 v4, s[48:51], s34 offen offset:1024 lds
    s_add_u32 m0, s98, 36864
    s_add_u32 s34, s14, 16384
    buffer_load_dwordx4 v3, s[48:51], s34 offen lds
    buffer_load_dwordx4 v4, s[48:51], s34 offen offset:1024 lds
    s_add_u32 m0, s98, 38912
    s_add_u32 s34, s15, 16384
    buffer_load_dwordx4 v3, s[48:51], s34 offen lds
    buffer_load_dwordx4 v4, s[48:51], s34 offen offset:1024 lds
    s_waitcnt vmcnt(25)
    s_mul_i32 s60, s95, 1171
    s_lshr_b32 s60, s60, 16
    s_mul_i32 s61, s60, 56
    s_sub_u32 s61, s95, s61
    s_lshl_b32 s60, s60, 14
    s_lshr_b32 s62, s61, 1
    s_lshl_b32 s62, s62, 16
    s_add_u32 s60, s60, s62
    s_and_b32 s61, s61, 1
    s_lshl_b32 s61, s61, 13
    s_add_u32 s60, s60, s61
    s_add_u32 s95, s95, 16
    buffer_load_dword v17, v16, s[48:51], s60 offen
    s_waitcnt vmcnt(25)
    s_mul_i32 s60, s95, 1171
    s_lshr_b32 s60, s60, 16
    s_mul_i32 s61, s60, 56
    s_sub_u32 s61, s95, s61
    s_lshl_b32 s60, s60, 14
    s_lshr_b32 s62, s61, 1
    s_lshl_b32 s62, s62, 16
    s_add_u32 s60, s60, s62
    s_and_b32 s61, s61, 1
    s_lshl_b32 s61, s61, 13
    s_add_u32 s60, s60, s61
    s_add_u32 s95, s95, 16
    buffer_load_dword v17, v16, s[48:51], s60 offen
    s_waitcnt vmcnt(1)
    s_mul_i32 s60, s95, 1171
    s_lshr_b32 s60, s60, 16
    s_mul_i32 s61, s60, 56
    s_sub_u32 s61, s95, s61
    s_lshl_b32 s60, s60, 14
    s_lshr_b32 s62, s61, 1
    s_lshl_b32 s62, s62, 16
    s_add_u32 s60, s60, s62
    s_and_b32 s61, s61, 1
    s_lshl_b32 s61, s61, 13
    s_add_u32 s60, s60, s61
    s_add_u32 s95, s95, 16
    buffer_load_dword v17, v16, s[48:51], s60 offen
    s_waitcnt vmcnt(2)
    s_mul_i32 s60, s95, 1171
    s_lshr_b32 s60, s60, 16
    s_mul_i32 s61, s60, 56
    s_sub_u32 s61, s95, s61
    s_lshl_b32 s60, s60, 14
    s_lshr_b32 s62, s61, 1
    s_lshl_b32 s62, s62, 16
    s_add_u32 s60, s60, s62
    s_and_b32 s61, s61, 1
    s_lshl_b32 s61, s61, 13
    s_add_u32 s60, s60, s61
    s_add_u32 s95, s95, 16
    buffer_load_dword v17, v16, s[48:51], s60 offen
    s_waitcnt vmcnt(4)
    ds_read_b64_tr_b16 v[128:129], v7 offset:0
    ds_read_b64_tr_b16 v[130:131], v7 offset:1024
    ds_read_b64_tr_b16 v[132:133], v8 offset:0
    ds_read_b64_tr_b16 v[134:135], v8 offset:1024
    ds_read_b64_tr_b16 v[136:137], v7 offset:2048
    ds_read_b64_tr_b16 v[138:139], v7 offset:3072
    ds_read_b64_tr_b16 v[140:141], v8 offset:2048
    ds_read_b64_tr_b16 v[142:143], v8 offset:3072
    ds_read_b64_tr_b16 v[144:145], v7 offset:4096
    ds_read_b64_tr_b16 v[146:147], v7 offset:5120
    ds_read_b64_tr_b16 v[148:149], v8 offset:4096
    ds_read_b64_tr_b16 v[150:151], v8 offset:5120
    ds_read_b64_tr_b16 v[152:153], v7 offset:6144
    ds_read_b64_tr_b16 v[154:155], v7 offset:7168
    ds_read_b64_tr_b16 v[156:157], v8 offset:6144
    ds_read_b64_tr_b16 v[158:159], v8 offset:7168
    ds_read_b64_tr_b16 v[160:161], v5 offset:0
    ds_read_b64_tr_b16 v[162:163], v5 offset:1024
    ds_read_b64_tr_b16 v[164:165], v6 offset:0
    ds_read_b64_tr_b16 v[166:167], v6 offset:1024
    ds_read_b64_tr_b16 v[168:169], v5 offset:2048
    ds_read_b64_tr_b16 v[170:171], v5 offset:3072
    ds_read_b64_tr_b16 v[172:173], v6 offset:2048
    ds_read_b64_tr_b16 v[174:175], v6 offset:3072
    ds_read_b64_tr_b16 v[176:177], v5 offset:4096
    ds_read_b64_tr_b16 v[178:179], v5 offset:5120
    ds_read_b64_tr_b16 v[180:181], v6 offset:4096
    ds_read_b64_tr_b16 v[182:183], v6 offset:5120
    ds_read_b64_tr_b16 v[184:185], v5 offset:6144
    ds_read_b64_tr_b16 v[186:187], v5 offset:7168
    ds_read_b64_tr_b16 v[188:189], v6 offset:6144
    ds_read_b64_tr_b16 v[190:191], v6 offset:7168
    ds_read_b64_tr_b16 v[192:193], v5 offset:32768
    ds_read_b64_tr_b16 v[194:195], v5 offset:33792
    ds_read_b64_tr_b16 v[196:197], v6 offset:32768
    ds_read_b64_tr_b16 v[198:199], v6 offset:33792
    ds_read_b64_tr_b16 v[200:201], v5 offset:34816
    ds_read_b64_tr_b16 v[202:203], v5 offset:35840
    ds_read_b64_tr_b16 v[204:205], v6 offset:34816
    ds_read_b64_tr_b16 v[206:207], v6 offset:35840
    ds_read_b64_tr_b16 v[208:209], v5 offset:36864
    ds_read_b64_tr_b16 v[210:211], v5 offset:37888
    ds_read_b64_tr_b16 v[212:213], v6 offset:36864
    ds_read_b64_tr_b16 v[214:215], v6 offset:37888
    ds_read_b64_tr_b16 v[216:217], v5 offset:38912
    ds_read_b64_tr_b16 v[218:219], v5 offset:39936
    ds_read_b64_tr_b16 v[220:221], v6 offset:38912
    ds_read_b64_tr_b16 v[222:223], v6 offset:39936
    s_waitcnt lgkmcnt(0)
    s_add_u32 m0, s98, 65536
    s_add_u32 s34, s16, 16384
    buffer_load_dwordx4 v3, s[48:51], s34 offen lds
    buffer_load_dwordx4 v4, s[48:51], s34 offen offset:1024 lds
    s_add_u32 m0, s98, 67584
    s_add_u32 s34, s17, 16384
    buffer_load_dwordx4 v3, s[48:51], s34 offen lds
    buffer_load_dwordx4 v4, s[48:51], s34 offen offset:1024 lds
    s_add_u32 m0, s98, 69632
    s_add_u32 s34, s11, 32768
    buffer_load_dwordx4 v3, s[48:51], s34 offen lds
    buffer_load_dwordx4 v4, s[48:51], s34 offen offset:1024 lds
    s_add_u32 m0, s98, 71680
    s_add_u32 s34, s12, 32768
    buffer_load_dwordx4 v3, s[48:51], s34 offen lds
    buffer_load_dwordx4 v4, s[48:51], s34 offen offset:1024 lds
    s_waitcnt vmcnt(10)
    s_mul_i32 s60, s95, 1171
    s_lshr_b32 s60, s60, 16
    s_mul_i32 s61, s60, 56
    s_sub_u32 s61, s95, s61
    s_lshl_b32 s60, s60, 14
    s_lshr_b32 s62, s61, 1
    s_lshl_b32 s62, s62, 16
    s_add_u32 s60, s60, s62
    s_and_b32 s61, s61, 1
    s_lshl_b32 s61, s61, 13
    s_add_u32 s60, s60, s61
    s_add_u32 s95, s95, 16
    buffer_load_dword v17, v16, s[48:51], s60 offen
    s_waitcnt vmcnt(10)
    s_mul_i32 s60, s95, 1171
    s_lshr_b32 s60, s60, 16
    s_mul_i32 s61, s60, 56
    s_sub_u32 s61, s95, s61
    s_lshl_b32 s60, s60, 14
    s_lshr_b32 s62, s61, 1
    s_lshl_b32 s62, s62, 16
    s_add_u32 s60, s60, s62
    s_and_b32 s61, s61, 1
    s_lshl_b32 s61, s61, 13
    s_add_u32 s60, s60, s61
    s_add_u32 s95, s95, 16
    buffer_load_dword v17, v16, s[48:51], s60 offen
    s_waitcnt vmcnt(10)
    s_mul_i32 s60, s95, 1171
    s_lshr_b32 s60, s60, 16
    s_mul_i32 s61, s60, 56
    s_sub_u32 s61, s95, s61
    s_lshl_b32 s60, s60, 14
    s_lshr_b32 s62, s61, 1
    s_lshl_b32 s62, s62, 16
    s_add_u32 s60, s60, s62
    s_and_b32 s61, s61, 1
    s_lshl_b32 s61, s61, 13
    s_add_u32 s60, s60, s61
    s_add_u32 s95, s95, 16
    buffer_load_dword v17, v16, s[48:51], s60 offen
    s_waitcnt vmcnt(2)
    s_mul_i32 s60, s95, 1171
    s_lshr_b32 s60, s60, 16
    s_mul_i32 s61, s60, 56
    s_sub_u32 s61, s95, s61
    s_lshl_b32 s60, s60, 14
    s_lshr_b32 s62, s61, 1
    s_lshl_b32 s62, s62, 16
    s_add_u32 s60, s60, s62
    s_and_b32 s61, s61, 1
    s_lshl_b32 s61, s61, 13
    s_add_u32 s60, s60, s61
    s_add_u32 s95, s95, 16
    buffer_load_dword v17, v16, s[48:51], s60 offen
    s_mov_b64 s[18:19], s[26:27]
    s_mov_b32 s62, s35
    s_mov_b32 s63, s35
    s_mov_b32 s61, 1
    s_load_dwordx8 s[36:43], s[32:33], s101 offset:0 glc
    s_load_dwordx8 s[20:27], s[32:33], s101 offset:32 glc
    s_branch Ljoin
Lswave:
    s_sub_u32 s52, s3, 4
    s_setprio 3
    v_lshlrev_b32 v1, 4, v0
    s_and_b32 s58, s2, 7
    s_lshl_b32 s58, s58, 5
    s_lshr_b32 s59, s2, 3
    s_add_u32 s58, s58, s59
    s_mov_b32 s48, s58
    s_lshl_b32 s57, s58, 13
    s_lshl_b32 s60, s52, 10
    s_add_u32 s57, s57, s60
    s_add_u32 s62, s57, 4096
    s_lshr_b32 s59, s52, 1
    s_lshl_b32 s53, s58, 1
    s_add_u32 s53, s53, s59
    s_and_b32 s54, s52, 1
    s_lshl_b32 s58, s58, 2
    s_lshl_b32 s60, s53, 8
    s_lshl_b32 s61, s54, 7
    s_add_u32 s60, s60, s61
    v_lshlrev_b32 v5, 1, v0
    v_add_u32 v5, s60, v5
    s_waitcnt lgkmcnt(0)
    s_mov_b32 s36, s4
    s_mov_b32 s37, s5
    s_mov_b32 s38, 2097152
    s_mov_b32 s39, 0x20000
    buffer_load_dwordx4 v[8:11], v1, s[36:39], s57 offen
    buffer_load_dwordx4 v[12:15], v1, s[36:39], s62 offen
    global_load_ushort v16, v5, s[6:7]
    global_load_ushort v17, v5, s[8:9]
    global_load_ushort v18, v5, s[10:11]
    global_load_ushort v19, v5, s[12:13]
    s_load_dword s34, s[32:33], 0
    s_load_dword s55, s[14:15], s58
    s_load_dword s56, s[16:17], s58
    s_mov_b32 s40, s32
    s_mov_b32 s41, s33
    s_mov_b32 s42, 20971520
    s_mov_b32 s43, 0x20000
    v_mov_b32 v2, 152064
    v_mov_b32 v3, 1
    s_cmp_lt_u32 s2, 224
    s_cbranch_scc1 Lcp_1048
    s_getpc_b64 s[60:61]
Lcp_1048_pc:
    s_sub_u32 s60, s60, Lcp_1048_pc-parallel_sum__ssm_conv_s4d__mixer_channel_mlp__prompt_kernel
    s_subb_u32 s61, s61, 0
    s_lshl_b32 s62, s52, 13
    v_lshl_add_u32 v6, v0, 7, s62
    v_min_u32 v6, Lend1-parallel_sum__ssm_conv_s4d__mixer_channel_mlp__prompt_kernel, v6
    global_load_dword v241, v6, s[60:61]
Lcp_1048:
    s_cmp_lg_u32 s52, 0
    s_cbranch_scc1 Lni_1049
    v_lshlrev_b32 v6, 2, v0
    v_add_u32 v6, 152064, v6
    v_mov_b32 v21, 0
    ds_write_b32 v6, v21
Lni_1049:
    s_waitcnt lgkmcnt(0)
    s_add_u32 s35, s34, 0x9E3779B9
    s_barrier
    s_lshr_b32 s59, s52, 1
    s_lshl_b32 s59, s59, 4
    s_lshr_b32 s55, s55, s59
    s_lshl_b32 s55, s55, 16
    s_lshr_b32 s56, s56, s59
    s_lshl_b32 s56, s56, 16
    s_waitcnt vmcnt(4)
    v_lshlrev_b32 v20, 16, v8
    v_lshlrev_b32 v21, 16, v12
    v_and_b32 v22, 0xffff0000, v8
    v_and_b32 v23, 0xffff0000, v12
    v_lshlrev_b32 v24, 16, v9
    v_lshlrev_b32 v25, 16, v13
    v_and_b32 v26, 0xffff0000, v9
    v_and_b32 v27, 0xffff0000, v13
    v_lshlrev_b32 v28, 16, v10
    v_lshlrev_b32 v29, 16, v14
    v_and_b32 v30, 0xffff0000, v10
    v_and_b32 v31, 0xffff0000, v14
    v_lshlrev_b32 v32, 16, v11
    v_lshlrev_b32 v33, 16, v15
    v_and_b32 v34, 0xffff0000, v11
    v_and_b32 v35, 0xffff0000, v15
    v_pk_add_f32 v[36:37], v[20:21], v[22:23]
    v_pk_add_f32 v[38:39], v[24:25], v[26:27]
    v_pk_add_f32 v[40:41], v[28:29], v[30:31]
    v_pk_add_f32 v[42:43], v[32:33], v[34:35]
    v_pk_add_f32 v[36:37], v[36:37], v[38:39]
    v_pk_add_f32 v[40:41], v[40:41], v[42:43]
    v_pk_add_f32 v[36:37], v[36:37], v[40:41]
    s_nop 1
    v_add_f32_dpp v36, v36, v36 quad_perm:[1,0,3,2] row_mask:0xf bank_mask:0xf
    v_add_f32_dpp v37, v37, v37 quad_perm:[1,0,3,2] row_mask:0xf bank_mask:0xf
    s_nop 0
    v_add_f32_dpp v36, v36, v36 quad_perm:[2,3,0,1] row_mask:0xf bank_mask:0xf
    v_add_f32_dpp v37, v37, v37 quad_perm:[2,3,0,1] row_mask:0xf bank_mask:0xf
    s_nop 0
    v_add_f32_dpp v36, v36, v36 row_half_mirror row_mask:0xf bank_mask:0xf
    v_add_f32_dpp v37, v37, v37 row_half_mirror row_mask:0xf bank_mask:0xf
    s_nop 0
    v_add_f32_dpp v36, v36, v36 row_mirror row_mask:0xf bank_mask:0xf
    v_add_f32_dpp v37, v37, v37 row_mirror row_mask:0xf bank_mask:0xf
    s_nop 1
    v_permlane16_swap_b32 v36, v37
    v_add_f32 v36, v36, v37
    v_mov_b32 v37, v36
    s_nop 1
    v_permlane32_swap_b32 v36, v37
    v_add_f32 v36, v36, v37
    v_mul_f32 v52, 0x3b000000, v36
    s_nop 0
    v_readlane_b32 s60, v52, 0
    v_readlane_b32 s61, v52, 16
    v_cvt_pk_bf16_f32 v52, v52, v52
    v_and_b32 v52, 0xffff0000, v52
    v_pk_add_f32 v[36:37], v[20:21], s[60:61] neg_lo:[0,1] neg_hi:[0,1]
    v_pk_add_f32 v[38:39], v[22:23], s[60:61] neg_lo:[0,1] neg_hi:[0,1]
    v_pk_add_f32 v[40:41], v[24:25], s[60:61] neg_lo:[0,1] neg_hi:[0,1]
    v_pk_add_f32 v[42:43], v[26:27], s[60:61] neg_lo:[0,1] neg_hi:[0,1]
    v_pk_add_f32 v[44:45], v[28:29], s[60:61] neg_lo:[0,1] neg_hi:[0,1]
    v_pk_add_f32 v[46:47], v[30:31], s[60:61] neg_lo:[0,1] neg_hi:[0,1]
    v_pk_add_f32 v[48:49], v[32:33], s[60:61] neg_lo:[0,1] neg_hi:[0,1]
    v_pk_add_f32 v[50:51], v[34:35], s[60:61] neg_lo:[0,1] neg_hi:[0,1]
    v_readlane_b32 s60, v52, 0
    v_readlane_b32 s61, v52, 16
    v_pk_mul_f32 v[36:37], v[36:37], v[36:37]
    v_pk_mul_f32 v[38:39], v[38:39], v[38:39]
    v_pk_fma_f32 v[36:37], v[40:41], v[40:41], v[36:37]
    v_pk_fma_f32 v[38:39], v[42:43], v[42:43], v[38:39]
    v_pk_fma_f32 v[36:37], v[44:45], v[44:45], v[36:37]
    v_pk_fma_f32 v[38:39], v[46:47], v[46:47], v[38:39]
    v_pk_fma_f32 v[36:37], v[48:49], v[48:49], v[36:37]
    v_pk_fma_f32 v[38:39], v[50:51], v[50:51], v[38:39]
    v_pk_add_f32 v[36:37], v[36:37], v[38:39]
    s_nop 1
    v_add_f32_dpp v36, v36, v36 quad_perm:[1,0,3,2] row_mask:0xf bank_mask:0xf
    v_add_f32_dpp v37, v37, v37 quad_perm:[1,0,3,2] row_mask:0xf bank_mask:0xf
    v_pk_add_f32 v[20:21], v[20:21], s[60:61] neg_lo:[0,1] neg_hi:[0,1]
    v_pk_add_f32 v[22:23], v[22:23], s[60:61] neg_lo:[0,1] neg_hi:[0,1]
    v_pk_add_f32 v[24:25], v[24:25], s[60:61] neg_lo:[0,1] neg_hi:[0,1]
    v_add_f32_dpp v36, v36, v36 quad_perm:[2,3,0,1] row_mask:0xf bank_mask:0xf
    v_add_f32_dpp v37, v37, v37 quad_perm:[2,3,0,1] row_mask:0xf bank_mask:0xf
    v_pk_add_f32 v[26:27], v[26:27], s[60:61] neg_lo:[0,1] neg_hi:[0,1]
    v_pk_add_f32 v[28:29], v[28:29], s[60:61] neg_lo:[0,1] neg_hi:[0,1]
    v_pk_add_f32 v[30:31], v[30:31], s[60:61] neg_lo:[0,1] neg_hi:[0,1]
    v_add_f32_dpp v36, v36, v36 row_half_mirror row_mask:0xf bank_mask:0xf
    v_add_f32_dpp v37, v37, v37 row_half_mirror row_mask:0xf bank_mask:0xf
    v_pk_add_f32 v[32:33], v[32:33], s[60:61] neg_lo:[0,1] neg_hi:[0,1]
    v_pk_add_f32 v[34:35], v[34:35], s[60:61] neg_lo:[0,1] neg_hi:[0,1]
    v_cvt_pk_bf16_f32 v40, v20, v21
    v_add_f32_dpp v36, v36, v36 row_mirror row_mask:0xf bank_mask:0xf
    v_add_f32_dpp v37, v37, v37 row_mirror row_mask:0xf bank_mask:0xf
    v_cvt_pk_bf16_f32 v41, v22, v23
    v_cvt_pk_bf16_f32 v42, v24, v25
    v_cvt_pk_bf16_f32 v43, v26, v27
    v_permlane16_swap_b32 v36, v37
    v_cvt_pk_bf16_f32 v44, v28, v29
    v_cvt_pk_bf16_f32 v45, v30, v31
    v_cvt_pk_bf16_f32 v46, v32, v33
    v_add_f32 v36, v36, v37
    v_mov_b32 v37, v36
    v_cvt_pk_bf16_f32 v47, v34, v35
    v_lshlrev_b32 v20, 16, v40
    v_and_b32 v21, 0xffff0000, v40
    v_permlane32_swap_b32 v36, v37
    v_lshlrev_b32 v22, 16, v41
    v_and_b32 v23, 0xffff0000, v41
    v_lshlrev_b32 v24, 16, v42
    v_add_f32 v36, v36, v37
    v_mul_f32 v53, 0x3b000000, v36
    v_cvt_pk_bf16_f32 v53, v53, v53
    v_and_b32 v53, 0xffff0000, v53
    v_add_f32 v53, 0x3727c5ac, v53
    v_cvt_pk_bf16_f32 v53, v53, v53
    v_and_b32 v53, 0xffff0000, v53
    v_sqrt_f32 v54, v53
    v_and_b32 v25, 0xffff0000, v42
    v_lshlrev_b32 v26, 16, v43
    v_and_b32 v27, 0xffff0000, v43
    v_cvt_pk_bf16_f32 v54, v54, v54
    v_and_b32 v54, 0xffff0000, v54
    v_rcp_f32 v55, v54
    v_lshlrev_b32 v28, 16, v44
    v_and_b32 v29, 0xffff0000, v44
    v_lshlrev_b32 v30, 16, v45
    v_readlane_b32 s62, v55, 0
    v_readlane_b32 s63, v55, 16
    v_and_b32 v31, 0xffff0000, v45
    v_lshlrev_b32 v32, 16, v46
    v_and_b32 v33, 0xffff0000, v46
    v_lshlrev_b32 v34, 16, v47
    v_and_b32 v35, 0xffff0000, v47
    v_pk_mul_f32 v[20:21], v[20:21], s[62:63]
    v_pk_mul_f32 v[22:23], v[22:23], s[62:63]
    v_pk_mul_f32 v[24:25], v[24:25], s[62:63]
    v_pk_mul_f32 v[26:27], v[26:27], s[62:63]
    v_pk_mul_f32 v[28:29], v[28:29], s[62:63]
    v_pk_mul_f32 v[30:31], v[30:31], s[62:63]
    v_pk_mul_f32 v[32:33], v[32:33], s[62:63]
    v_pk_mul_f32 v[34:35], v[34:35], s[62:63]
    s_mul_i32 s60, s52, 2112
    s_add_u32 s60, s60, 153216
    v_lshl_add_u32 v6, v0, 5, s60
    v_cvt_pk_bf16_f32 v8, v20, v21
    v_cvt_pk_bf16_f32 v9, v22, v23
    v_cvt_pk_bf16_f32 v10, v24, v25
    v_cvt_pk_bf16_f32 v11, v26, v27
    v_cvt_pk_bf16_f32 v12, v28, v29
    v_cvt_pk_bf16_f32 v13, v30, v31
    v_cvt_pk_bf16_f32 v14, v32, v33
    v_cvt_pk_bf16_f32 v15, v34, v35
    ds_write_b128 v6, v[8:11]
    ds_write_b128 v6, v[12:15] offset:16
    s_waitcnt lgkmcnt(0)
    s_mov_b64 exec, 1
    ds_add_u32 v2, v3 offset:4
    s_mov_b64 exec, -1
    v_bfe_u32 v6, v0, 2, 2
    v_mul_u32_u24 v6, 2112, v6
    v_lshrrev_b32 v7, 4, v0
    v_lshl_add_u32 v6, v7, 5, v6
    v_and_b32 v7, 3, v0
    v_lshl_add_u32 v6, v7, 3, v6
    s_lshl_b32 s60, s52, 9
    s_add_u32 s60, s60, 153216
    v_add_u32 v6, s60, v6
    s_lshl_b32 s57, s48, 14
    s_lshl_b32 s60, s52, 12
    s_add_u32 s57, s57, s60
    s_add_u32 s98, s57, 1048576
    v_mov_b32 v162, s35
    v_mov_b32 v163, s35
    v_mov_b32 v166, s35
    v_mov_b32 v167, s35
    v_mov_b32 v170, s35
    v_mov_b32 v171, s35
    v_mov_b32 v174, s35
    v_mov_b32 v175, s35
    v_lshlrev_b32 v20, 16, v8
    v_and_b32 v21, 0xffff0000, v8
    v_lshlrev_b32 v22, 16, v9
    v_and_b32 v23, 0xffff0000, v9
    v_lshlrev_b32 v24, 16, v10
    v_and_b32 v25, 0xffff0000, v10
    v_lshlrev_b32 v26, 16, v11
    v_and_b32 v27, 0xffff0000, v11
    v_lshlrev_b32 v28, 16, v12
    v_and_b32 v29, 0xffff0000, v12
    v_lshlrev_b32 v30, 16, v13
    v_and_b32 v31, 0xffff0000, v13
    v_lshlrev_b32 v32, 16, v14
    v_and_b32 v33, 0xffff0000, v14
    v_lshlrev_b32 v34, 16, v15
    v_and_b32 v35, 0xffff0000, v15
    s_mov_b32 s94, 65536
Lw_1050:
    ds_read_b32 v4, v2 offset:4
    s_waitcnt lgkmcnt(0)
    v_cmp_gt_u32 vcc, 4, v4
    s_cbranch_vccz Lwd_1051
    s_sub_u32 s94, s94, 1
    s_cbranch_scc0 Lw_1050
Lwd_1051:
    ds_read_b64_tr_b16 v[160:161], v6 offset:0
    ds_read_b64_tr_b16 v[164:165], v6 offset:128
    ds_read_b64_tr_b16 v[168:169], v6 offset:256
    ds_read_b64_tr_b16 v[172:173], v6 offset:384
    v_pk_mul_f32 v[38:39], v[20:21], v[20:21]
    v_pk_mul_f32 v[40:41], v[22:23], v[22:23]
    v_pk_add_f32 v[36:37], v[20:21], v[22:23]
    s_waitcnt lgkmcnt(3)
    buffer_store_dwordx4 v[160:163], v1, s[40:43], s98 offen offset:0 sc1
    s_waitcnt lgkmcnt(2)
    buffer_store_dwordx4 v[164:167], v1, s[40:43], s98 offen offset:1024 sc1
    s_waitcnt lgkmcnt(1)
    buffer_store_dwordx4 v[168:171], v1, s[40:43], s98 offen offset:2048 sc1
    s_waitcnt lgkmcnt(0)
    buffer_store_dwordx4 v[172:175], v1, s[40:43], s98 offen offset:3072 sc1
    v_pk_add_f32 v[36:37], v[36:37], v[24:25]
    v_pk_fma_f32 v[38:39], v[24:25], v[24:25], v[38:39]
    v_pk_add_f32 v[36:37], v[36:37], v[26:27]
    v_pk_fma_f32 v[40:41], v[26:27], v[26:27], v[40:41]
    v_pk_add_f32 v[36:37], v[36:37], v[28:29]
    v_pk_fma_f32 v[38:39], v[28:29], v[28:29], v[38:39]
    v_pk_add_f32 v[36:37], v[36:37], v[30:31]
    v_pk_fma_f32 v[40:41], v[30:31], v[30:31], v[40:41]
    v_pk_add_f32 v[36:37], v[36:37], v[32:33]
    v_pk_fma_f32 v[38:39], v[32:33], v[32:33], v[38:39]
    v_pk_add_f32 v[36:37], v[36:37], v[34:35]
    v_pk_fma_f32 v[40:41], v[34:35], v[34:35], v[40:41]
    v_pk_add_f32 v[38:39], v[38:39], v[40:41]
    v_add_f32_dpp v36, v36, v36 quad_perm:[1,0,3,2] row_mask:0xf bank_mask:0xf
    v_add_f32_dpp v37, v37, v37 quad_perm:[1,0,3,2] row_mask:0xf bank_mask:0xf
    v_add_f32_dpp v38, v38, v38 quad_perm:[1,0,3,2] row_mask:0xf bank_mask:0xf
    v_add_f32_dpp v39, v39, v39 quad_perm:[1,0,3,2] row_mask:0xf bank_mask:0xf
    v_add_f32_dpp v36, v36, v36 quad_perm:[2,3,0,1] row_mask:0xf bank_mask:0xf
    v_add_f32_dpp v37, v37, v37 quad_perm:[2,3,0,1] row_mask:0xf bank_mask:0xf
    v_add_f32_dpp v38, v38, v38 quad_perm:[2,3,0,1] row_mask:0xf bank_mask:0xf
    v_add_f32_dpp v39, v39, v39 quad_perm:[2,3,0,1] row_mask:0xf bank_mask:0xf
    v_add_f32_dpp v36, v36, v36 row_half_mirror row_mask:0xf bank_mask:0xf
    v_add_f32_dpp v37, v37, v37 row_half_mirror row_mask:0xf bank_mask:0xf
    v_add_f32_dpp v38, v38, v38 row_half_mirror row_mask:0xf bank_mask:0xf
    v_add_f32_dpp v39, v39, v39 row_half_mirror row_mask:0xf bank_mask:0xf
    v_add_f32_dpp v36, v36, v36 row_mirror row_mask:0xf bank_mask:0xf
    v_add_f32_dpp v37, v37, v37 row_mirror row_mask:0xf bank_mask:0xf
    v_add_f32_dpp v38, v38, v38 row_mirror row_mask:0xf bank_mask:0xf
    v_add_f32_dpp v39, v39, v39 row_mirror row_mask:0xf bank_mask:0xf
    v_permlane16_swap_b32 v36, v37
    s_nop 0
    v_permlane16_swap_b32 v38, v39
    v_add_f32 v36, v36, v37
    v_add_f32 v37, v38, v39
    v_mov_b32 v44, v36
    v_mov_b32 v45, v37
    s_nop 0
    v_permlane32_swap_b32 v36, v44
    v_permlane32_swap_b32 v37, v45
    v_add_f32 v36, v36, v44
    v_add_f32 v37, v37, v45
    v_mul_f32 v36, 0x3b000000, v36
    v_mul_f32 v37, 0x3b000000, v37
    v_fma_f32 v37, -v36, v36, v37
    v_max_f32 v37, 0, v37
    v_cvt_pk_bf16_f32 v36, v36, v36
    v_and_b32 v36, 0xffff0000, v36
    v_cvt_pk_bf16_f32 v37, v37, v37
    v_and_b32 v37, 0xffff0000, v37
    v_add_f32 v37, 0x3727c5ac, v37
    v_cvt_pk_bf16_f32 v37, v37, v37
    v_and_b32 v37, 0xffff0000, v37
    v_sqrt_f32 v37, v37
    s_nop 0
    v_cvt_pk_bf16_f32 v37, v37, v37
    v_and_b32 v37, 0xffff0000, v37
    v_fma_f32 v36, v36, v54, v52
    v_mul_f32 v37, v37, v54
    v_sub_f32 v36, 0, v36
    v_cvt_pk_bf16_f32 v38, v36, v36
    v_and_b32 v38, 0xffff0000, v38
    v_cvt_pk_bf16_f32 v39, v37, v37
    v_and_b32 v39, 0xffff0000, v39
    v_sub_f32 v36, v36, v38
    v_sub_f32 v37, v37, v39
    v_cvt_pk_bf16_f32 v44, v38, v36
    v_cvt_pk_bf16_f32 v45, v38, v39
    v_cvt_pk_bf16_f32 v46, v37, v36
    v_mov_b32 v47, s35
    v_and_b32 v6, 16, v0
    v_lshlrev_b32 v6, 2, v6
    s_lshl_b32 s60, s48, 7
    s_lshl_b32 s61, s52, 4
    s_add_u32 s60, s60, s61
    s_add_u32 s60, s60, 32768
    s_mov_b64 exec, 0x10001
    buffer_store_dwordx4 v[44:47], v6, s[40:43], s60 offen sc1
    s_mov_b64 exec, -1
    s_setprio 0
    s_waitcnt vmcnt(5) lgkmcnt(0)
    v_mov_b32 v56, s55
    v_mul_f32 v56, 0x3fb8aa3b, v56
    v_exp_f32 v56, v56
    s_nop 0
    v_cvt_pk_bf16_f32 v56, v56, v56
    v_and_b32 v56, 0xffff0000, v56
    v_lshlrev_b32 v16, 16, v16
    v_lshlrev_b32 v17, 16, v17
    v_lshlrev_b32 v18, 16, v18
    v_lshlrev_b32 v19, 16, v19
    v_mul_f32 v16, 0x3fb8aa3b, v16
    v_exp_f32 v16, v16
    s_nop 0
    v_cvt_pk_bf16_f32 v16, v16, v16
    v_and_b32 v16, 0xffff0000, v16
    v_mul_f32 v16, v16, v56
    v_mul_f32 v17, v17, v56
    v_mul_f32 v16, 0xbfb8aa3b, v16
    v_mul_f32 v17, 0x3e22f983, v17
    v_add_f32 v56, v56, v56
    v_mul_f32 v112, v18, v56
    v_mul_f32 v113, -v19, v56
    v_mov_b32 v57, v16
    v_fract_f32 v58, v17
    v_mul_f32 v59, 0x41800000, v16
    v_mul_f32 v60, 0x41800000, v17
    v_fract_f32 v60, v60
    v_mul_f32 v61, 0x43800000, v16
    v_mul_f32 v62, 0x43800000, v17
    v_fract_f32 v62, v62
    v_exp_f32 v57, v57
    v_cos_f32 v66, v58
    v_sin_f32 v67, v58
    v_exp_f32 v59, v59
    v_cos_f32 v96, v60
    v_sin_f32 v97, v60
    v_exp_f32 v61, v61
    v_cos_f32 v98, v62
    v_sin_f32 v99, v62
    v_mul_f32 v66, v66, v57
    v_mul_f32 v67, v67, v57
    v_mul_f32 v96, v96, v59
    v_mul_f32 v97, v97, v59
    v_mul_f32 v98, v98, v61
    v_mul_f32 v99, v99, v61
    v_mov_b32 v116, v96
    v_sub_f32 v117, 0, v97
    s_lshr_b32 s60, s52, 1
    s_mul_i32 s57, s60, 22304
    s_add_u32 s57, s57, 98304
    s_lshl_b32 s61, s54, 8
    s_add_u32 s61, s61, s57
    v_lshlrev_b32 v150, 2, v0
    v_add_u32 v150, s61, v150
    v_cvt_pk_bf16_f32 v6, v112, v113
    v_mov_b32 v5, 0x3f80
    ds_write_b32 v150, v6 offset:0
    ds_write_b32 v150, v5 offset:8704
    v_mul_f32 v114, v112, v116
    v_cvt_pk_bf16_f32 v10, v66, v67
    v_mul_f32 v115, v112, v117
    ds_write_b32 v150, v10 offset:9248
    v_fma_f32 v114, -v113, v117, v114
    v_mul_f32 v68, v66, v66
    v_fma_f32 v115, v113, v116, v115
    v_mul_f32 v69, v66, v67
    v_cvt_pk_bf16_f32 v7, v114, v115
    v_fma_f32 v68, -v67, v67, v68
    ds_write_b32 v150, v7 offset:544
    v_fma_f32 v69, v67, v66, v69
    v_mul_f32 v112, v114, v116
    v_cvt_pk_bf16_f32 v11, v68, v69
    v_mul_f32 v113, v114, v117
    ds_write_b32 v150, v11 offset:9792
    v_fma_f32 v112, -v115, v117, v112
    v_mul_f32 v70, v68, v66
    v_fma_f32 v113, v115, v116, v113
    v_mul_f32 v71, v68, v67
    v_cvt_pk_bf16_f32 v8, v112, v113
    v_fma_f32 v70, -v69, v67, v70
    ds_write_b32 v150, v8 offset:1088
    v_fma_f32 v71, v69, v66, v71
    v_mul_f32 v114, v112, v116
    v_cvt_pk_bf16_f32 v9, v70, v71
    v_mul_f32 v115, v112, v117
    ds_write_b32 v150, v9 offset:10336
    v_fma_f32 v114, -v113, v117, v114
    v_mul_f32 v72, v70, v66
    v_fma_f32 v115, v113, v116, v115
    v_mul_f32 v73, v70, v67
    v_cvt_pk_bf16_f32 v6, v114, v115
    v_fma_f32 v72, -v71, v67, v72
    ds_write_b32 v150, v6 offset:1632
    v_fma_f32 v73, v71, v66, v73
    v_mul_f32 v112, v114, v116
    v_cvt_pk_bf16_f32 v10, v72, v73
    v_mul_f32 v113, v114, v117
    ds_write_b32 v150, v10 offset:10880
    v_fma_f32 v112, -v115, v117, v112
    v_mul_f32 v74, v72, v66
    v_fma_f32 v113, v115, v116, v113
    v_mul_f32 v75, v72, v67
    v_cvt_pk_bf16_f32 v7, v112, v113
    v_fma_f32 v74, -v73, v67, v74
    ds_write_b32 v150, v7 offset:2176
    v_fma_f32 v75, v73, v66, v75
    v_mul_f32 v114, v112, v116
    v_cvt_pk_bf16_f32 v11, v74, v75
    v_mul_f32 v115, v112, v117
    ds_write_b32 v150, v11 offset:11424
    v_fma_f32 v114, -v113, v117, v114
    v_mul_f32 v76, v74, v66
    v_fma_f32 v115, v113, v116, v115
    v_mul_f32 v77, v74, v67
    v_cvt_pk_bf16_f32 v8, v114, v115
    v_fma_f32 v76, -v75, v67, v76
    ds_write_b32 v150, v8 offset:2720
    v_fma_f32 v77, v75, v66, v77
    v_mul_f32 v112, v114, v116
    v_cvt_pk_bf16_f32 v9, v76, v77
    v_mul_f32 v113, v114, v117
    ds_write_b32 v150, v9 offset:11968
    v_fma_f32 v112, -v115, v117, v112
    v_mul_f32 v78, v76, v66
    v_fma_f32 v113, v115, v116, v113
    v_mul_f32 v79, v76, v67
    v_cvt_pk_bf16_f32 v6, v112, v113
    v_fma_f32 v78, -v77, v67, v78
    ds_write_b32 v150, v6 offset:3264
    v_fma_f32 v79, v77, v66, v79
    v_mul_f32 v114, v112, v116
    v_cvt_pk_bf16_f32 v10, v78, v79
    v_mul_f32 v115, v112, v117
    ds_write_b32 v150, v10 offset:12512
    v_fma_f32 v114, -v113, v117, v114
    v_mul_f32 v80, v78, v66
    v_fma_f32 v115, v113, v116, v115
    v_mul_f32 v81, v78, v67
    v_cvt_pk_bf16_f32 v7, v114, v115
    v_fma_f32 v80, -v79, v67, v80
    ds_write_b32 v150, v7 offset:3808
    v_fma_f32 v81, v79, v66, v81
    v_mul_f32 v112, v114, v116
    v_cvt_pk_bf16_f32 v11, v80, v81
    v_mul_f32 v113, v114, v117
    ds_write_b32 v150, v11 offset:13056
    v_fma_f32 v112, -v115, v117, v112
    v_mul_f32 v82, v80, v66
    v_fma_f32 v113, v115, v116, v113
    v_mul_f32 v83, v80, v67
    v_cvt_pk_bf16_f32 v8, v112, v113
    v_fma_f32 v82, -v81, v67, v82
    ds_write_b32 v150, v8 offset:4352
    v_fma_f32 v83, v81, v66, v83
    v_mul_f32 v114, v112, v116
    v_cvt_pk_bf16_f32 v9, v82, v83
    v_mul_f32 v115, v112, v117
    ds_write_b32 v150, v9 offset:13600
    v_fma_f32 v114, -v113, v117, v114
    v_mul_f32 v84, v82, v66
    v_fma_f32 v115, v113, v116, v115
    v_mul_f32 v85, v82, v67
    v_cvt_pk_bf16_f32 v6, v114, v115
    v_fma_f32 v84, -v83, v67, v84
    ds_write_b32 v150, v6 offset:4896
    v_fma_f32 v85, v83, v66, v85
    v_mul_f32 v112, v114, v116
    v_cvt_pk_bf16_f32 v10, v84, v85
    v_mul_f32 v113, v114, v117
    ds_write_b32 v150, v10 offset:14144
    v_fma_f32 v112, -v115, v117, v112
    v_mul_f32 v86, v84, v66
    v_fma_f32 v113, v115, v116, v113
    v_mul_f32 v87, v84, v67
    v_cvt_pk_bf16_f32 v7, v112, v113
    v_fma_f32 v86, -v85, v67, v86
    ds_write_b32 v150, v7 offset:5440
    v_fma_f32 v87, v85, v66, v87
    v_mul_f32 v114, v112, v116
    v_cvt_pk_bf16_f32 v11, v86, v87
    v_mul_f32 v115, v112, v117
    ds_write_b32 v150, v11 offset:14688
    v_fma_f32 v114, -v113, v117, v114
    v_mul_f32 v88, v86, v66
    v_fma_f32 v115, v113, v116, v115
    v_mul_f32 v89, v86, v67
    v_cvt_pk_bf16_f32 v8, v114, v115
    v_fma_f32 v88, -v87, v67, v88
    ds_write_b32 v150, v8 offset:5984
    v_fma_f32 v89, v87, v66, v89
    v_mul_f32 v112, v114, v116
    v_cvt_pk_bf16_f32 v9, v88, v89
    v_mul_f32 v113, v114, v117
    ds_write_b32 v150, v9 offset:15232
    v_fma_f32 v112, -v115, v117, v112
    v_mul_f32 v90, v88, v66
    v_fma_f32 v113, v115, v116, v113
    v_mul_f32 v91, v88, v67
    v_cvt_pk_bf16_f32 v6, v112, v113
    v_fma_f32 v90, -v89, v67, v90
    ds_write_b32 v150, v6 offset:6528
    v_fma_f32 v91, v89, v66, v91
    v_mul_f32 v114, v112, v116
    v_cvt_pk_bf16_f32 v10, v90, v91
    v_mul_f32 v115, v112, v117
    ds_write_b32 v150, v10 offset:15776
    v_fma_f32 v114, -v113, v117, v114
    v_mul_f32 v92, v90, v66
    v_fma_f32 v115, v113, v116, v115
    v_mul_f32 v93, v90, v67
    v_cvt_pk_bf16_f32 v7, v114, v115
    v_fma_f32 v92, -v91, v67, v92
    ds_write_b32 v150, v7 offset:7072
    v_fma_f32 v93, v91, v66, v93
    v_mul_f32 v112, v114, v116
    v_cvt_pk_bf16_f32 v11, v92, v93
    v_mul_f32 v113, v114, v117
    ds_write_b32 v150, v11 offset:16320
    v_fma_f32 v112, -v115, v117, v112
    v_mul_f32 v94, v92, v66
    v_fma_f32 v113, v115, v116, v113
    v_mul_f32 v95, v92, v67
    v_cvt_pk_bf16_f32 v8, v112, v113
    v_fma_f32 v94, -v93, v67, v94
    ds_write_b32 v150, v8 offset:7616
    v_fma_f32 v95, v93, v66, v95
    v_mul_f32 v114, v112, v116
    v_cvt_pk_bf16_f32 v9, v94, v95
    v_mul_f32 v115, v112, v117
    ds_write_b32 v150, v9 offset:16864
    v_fma_f32 v114, -v113, v117, v114
    v_fma_f32 v115, v113, v116, v115
    v_cvt_pk_bf16_f32 v6, v114, v115
    ds_write_b32 v150, v6 offset:8160
    v_cvt_pk_bf16_f32 v7, v98, v99
    ds_write_b32 v150, v7 offset:17408
    v_mul_f32 v120, v98, v68
    v_mul_f32 v121, v98, v69
    v_fma_f32 v120, -v99, v69, v120
    v_fma_f32 v121, v99, v68, v121
    v_cvt_pk_bf16_f32 v8, v120, v121
    ds_write_b32 v150, v8 offset:17952
    v_mul_f32 v122, v98, v72
    v_mul_f32 v123, v98, v73
    v_fma_f32 v122, -v99, v73, v122
    v_fma_f32 v123, v99, v72, v123
    v_cvt_pk_bf16_f32 v6, v122, v123
    ds_write_b32 v150, v6 offset:18496
    v_mul_f32 v124, v98, v76
    v_mul_f32 v125, v98, v77
    v_fma_f32 v124, -v99, v77, v124
    v_fma_f32 v125, v99, v76, v125
    v_cvt_pk_bf16_f32 v7, v124, v125
    ds_write_b32 v150, v7 offset:19040
    v_mul_f32 v118, v98, v80
    v_mul_f32 v119, v98, v81
    v_fma_f32 v118, -v99, v81, v118
    v_fma_f32 v119, v99, v80, v119
    v_cvt_pk_bf16_f32 v8, v118, v119
    ds_write_b32 v150, v8 offset:19584
    v_mul_f32 v120, v98, v84
    v_mul_f32 v121, v98, v85
    v_fma_f32 v120, -v99, v85, v120
    v_fma_f32 v121, v99, v84, v121
    v_cvt_pk_bf16_f32 v6, v120, v121
    ds_write_b32 v150, v6 offset:20128
    v_mul_f32 v122, v98, v88
    v_mul_f32 v123, v98, v89
    v_fma_f32 v122, -v99, v89, v122
    v_fma_f32 v123, v99, v88, v123
    v_cvt_pk_bf16_f32 v7, v122, v123
    ds_write_b32 v150, v7 offset:20672
    v_mul_f32 v124, v98, v92
    v_mul_f32 v125, v98, v93
    v_fma_f32 v124, -v99, v93, v124
    v_fma_f32 v125, v99, v92, v125
    v_cvt_pk_bf16_f32 v8, v124, v125
    ds_write_b32 v150, v8 offset:21216
    v_mul_f32 v118, v98, v96
    v_mul_f32 v119, v98, v97
    v_fma_f32 v118, -v99, v97, v118
    v_fma_f32 v119, v99, v96, v119
    v_cvt_pk_bf16_f32 v6, v118, v119
    ds_write_b32 v150, v6 offset:21760
    s_waitcnt lgkmcnt(0)
    s_mov_b64 exec, 1
    ds_add_u32 v2, v3 offset:4
    s_mov_b64 exec, -1
    v_and_b32 v6, 15, v0
    v_lshrrev_b32 v7, 4, v0
    v_lshlrev_b32 v8, 4, v7
    v_add_u32 v8, s57, v8
    v_lshlrev_b32 v9, 5, v6
    v_mad_u32_u24 v151, v9, 17, v8
    v_lshrrev_b32 v10, 2, v6
    v_and_b32 v11, 3, v6
    s_lshr_b32 s60, s52, 1
    s_mul_i32 s59, s60, 4576
    s_add_u32 s59, s59, 142912
    s_cmp_eq_u32 s54, 1
    s_cbranch_scc1 Lp1_1052
    v_add_u32 v152, 8704, v151
    v_and_b32 v12, 1, v10
    v_lshl_add_u32 v12, v12, 1, v11
    v_min_u32 v12, 4, v12
    v_lshrrev_b32 v13, 1, v10
    v_mad_u32_u24 v12, v13, 5, v12
    v_add_u32 v12, 16, v12
    s_add_u32 s60, s59, 4088
    v_lshl_add_u32 v13, v7, 3, v9
    v_sub_u32 v154, s60, v13
    v_lshrrev_b32 v13, 1, v7
    v_lshl_add_u32 v13, v13, 9, v9
    v_and_b32 v14, 1, v7
    v_lshl_add_u32 v13, v14, 4, v13
    s_add_u32 s60, s59, 3056
    v_sub_u32 v155, s60, v13
    s_branch Lp1d_1053
Lp1_1052:
    v_lshl_add_u32 v12, v10, 1, v11
    v_min_u32 v12, 8, v12
    v_add_u32 v12, 32, v12
    v_lshlrev_b32 v12, 5, v12
    v_mad_u32_u24 v152, v12, 17, v8
    v_min_u32 v12, 2, v11
    v_mad_u32_u24 v12, v10, 3, v12
    v_add_u32 v12, 26, v12
    s_add_u32 s60, s59, 3576
    v_lshl_add_u32 v13, v7, 3, v9
    v_sub_u32 v154, s60, v13
    v_lshl_add_u32 v13, v7, 9, v9
    s_add_u32 s60, s59, 2016
    v_sub_u32 v155, s60, v13
Lp1d_1053:
    v_lshlrev_b32 v12, 5, v12
    v_mad_u32_u24 v153, v12, 17, v8
    v_mul_f32 v100, v98, v98
    v_mul_f32 v101, v98, v99
    v_fma_f32 v100, -v99, v99, v100
    v_fma_f32 v101, v99, v98, v101
    v_mul_f32 v102, v100, v98
    v_mul_f32 v103, v100, v99
    v_fma_f32 v102, -v101, v99, v102
    v_fma_f32 v103, v101, v98, v103
    v_mul_f32 v104, v100, v100
    v_mul_f32 v105, v100, v101
    v_fma_f32 v104, -v101, v101, v104
    v_fma_f32 v105, v101, v100, v105
    v_mul_f32 v106, v104, v98
    v_mul_f32 v107, v104, v99
    v_fma_f32 v106, -v105, v99, v106
    v_fma_f32 v107, v105, v98, v107
    v_mul_f32 v108, v104, v100
    v_mul_f32 v109, v104, v101
    v_fma_f32 v108, -v105, v101, v108
    v_fma_f32 v109, v105, v100, v109
    v_mul_f32 v110, v104, v102
    v_mul_f32 v111, v104, v103
    v_fma_f32 v110, -v105, v103, v110
    v_fma_f32 v111, v105, v102, v111
    v_cvt_pk_bf16_f32 v128, v100, v101
    v_mul_f32 v120, v100, v72
    v_mul_f32 v121, v100, v73
    v_fma_f32 v120, -v101, v73, v120
    v_fma_f32 v121, v101, v72, v121
    v_cvt_pk_bf16_f32 v129, v120, v121
    v_mul_f32 v122, v100, v80
    v_mul_f32 v123, v100, v81
    v_fma_f32 v122, -v101, v81, v122
    v_fma_f32 v123, v101, v80, v123
    v_cvt_pk_bf16_f32 v130, v122, v123
    v_mul_f32 v124, v100, v88
    v_mul_f32 v125, v100, v89
    v_fma_f32 v124, -v101, v89, v124
    v_fma_f32 v125, v101, v88, v125
    v_cvt_pk_bf16_f32 v131, v124, v125
    v_mul_f32 v118, v100, v96
    v_mul_f32 v119, v100, v97
    v_fma_f32 v118, -v101, v97, v118
    v_fma_f32 v119, v101, v96, v119
    v_cvt_pk_bf16_f32 v132, v118, v119
    v_cvt_pk_bf16_f32 v133, v102, v103
    v_mul_f32 v122, v102, v72
    v_mul_f32 v123, v102, v73
    v_fma_f32 v122, -v103, v73, v122
    v_fma_f32 v123, v103, v72, v123
    v_cvt_pk_bf16_f32 v134, v122, v123
    v_mul_f32 v124, v102, v80
    v_mul_f32 v125, v102, v81
    v_fma_f32 v124, -v103, v81, v124
    v_fma_f32 v125, v103, v80, v125
    s_mov_b32 s94, 65536
Lw_1054:
    ds_read_b32 v4, v2 offset:4
    s_waitcnt lgkmcnt(0)
    v_cmp_gt_u32 vcc, 8, v4
    s_cbranch_vccz Lwd_1055
    s_sub_u32 s94, s94, 1
    s_cbranch_scc0 Lw_1054
Lwd_1055:
    ds_read_b128 v[160:163], v151 offset:0
    ds_read_b128 v[192:195], v152 offset:0
    ds_read_b128 v[164:167], v151 offset:64
    ds_read_b128 v[196:199], v152 offset:64
    ds_read_b128 v[168:171], v151 offset:128
    ds_read_b128 v[200:203], v152 offset:128
    ds_read_b128 v[172:175], v151 offset:192
    ds_read_b128 v[204:207], v152 offset:192
    ds_read_b128 v[176:179], v151 offset:256
    ds_read_b128 v[208:211], v152 offset:256
    ds_read_b128 v[180:183], v151 offset:320
    ds_read_b128 v[212:215], v152 offset:320
    ds_read_b128 v[184:187], v151 offset:384
    ds_read_b128 v[216:219], v152 offset:384
    ds_read_b128 v[188:191], v151 offset:448
    ds_read_b128 v[220:223], v152 offset:448
    v_cvt_pk_bf16_f32 v135, v124, v125
    v_mul_f32 v118, v102, v88
    v_mul_f32 v119, v102, v89
    v_fma_f32 v118, -v103, v89, v118
    v_fma_f32 v119, v103, v88, v119
    v_cvt_pk_bf16_f32 v136, v118, v119
    v_mul_f32 v120, v102, v96
    v_mul_f32 v121, v102, v97
    v_fma_f32 v120, -v103, v97, v120
    v_fma_f32 v121, v103, v96, v121
    v_cvt_pk_bf16_f32 v137, v120, v121
    v_cvt_pk_bf16_f32 v138, v104, v105
    v_mul_f32 v124, v104, v80
    v_mul_f32 v125, v104, v81
    v_fma_f32 v124, -v105, v81, v124
    v_fma_f32 v125, v105, v80, v125
    v_cvt_pk_bf16_f32 v139, v124, v125
    v_mul_f32 v118, v104, v96
    v_mul_f32 v119, v104, v97
    v_fma_f32 v118, -v105, v97, v118
    v_fma_f32 v119, v105, v96, v119
    v_cvt_pk_bf16_f32 v140, v118, v119
    v_cvt_pk_bf16_f32 v141, v106, v107
    v_mul_f32 v122, v106, v80
    v_mul_f32 v123, v106, v81
    v_fma_f32 v122, -v107, v81, v122
    v_fma_f32 v123, v107, v80, v123
    v_cvt_pk_bf16_f32 v142, v122, v123
    v_mul_f32 v124, v106, v96
    v_mul_f32 v125, v106, v97
    v_fma_f32 v124, -v107, v97, v124
    v_fma_f32 v125, v107, v96, v125
    v_cvt_pk_bf16_f32 v143, v124, v125
    v_cvt_pk_bf16_f32 v144, v108, v109
    v_mul_f32 v120, v108, v80
    v_mul_f32 v121, v108, v81
    v_fma_f32 v120, -v109, v81, v120
    v_fma_f32 v121, v109, v80, v121
    v_cvt_pk_bf16_f32 v145, v120, v121
    v_mul_f32 v122, v108, v96
    v_mul_f32 v123, v108, v97
    v_fma_f32 v122, -v109, v97, v122
    v_fma_f32 v123, v109, v96, v123
    v_cvt_pk_bf16_f32 v146, v122, v123
    v_cvt_pk_bf16_f32 v147, v110, v111
    v_mul_f32 v118, v110, v80
    v_mul_f32 v119, v110, v81
    v_fma_f32 v118, -v111, v81, v118
    v_fma_f32 v119, v111, v80, v119
    v_cvt_pk_bf16_f32 v148, v118, v119
    v_mul_f32 v120, v110, v96
    v_mul_f32 v121, v110, v97
    v_fma_f32 v120, -v111, v97, v120
    v_fma_f32 v121, v111, v96, v121
    v_cvt_pk_bf16_f32 v149, v120, v121
    v_lshrrev_b32 v6, 2, v0
    s_lshl_b32 s60, s52, 6
    v_add_u32 v6, s60, v6
    v_and_b32 v7, 3, v0
    v_lshlrev_b32 v156, 14, v6
    v_lshl_add_u32 v156, v7, 4, v156
    s_lshl_b32 s44, s48, 6
    s_add_u32 s44, s44, 1048576
    s_add_u32 s45, s44, 262144
    s_add_u32 s46, s44, 524288
    s_add_u32 s47, s44, 786432
    v_bfe_u32 v7, v0, 1, 1
    v_mul_u32_u24 v7, 22304, v7
    v_lshl_add_u32 v157, v6, 4, v7
    v_and_b32 v7, 1, v0
    v_lshl_add_u32 v157, v7, 3, v157
    v_add_u32 v157, 98336, v157
    s_waitcnt lgkmcnt(0)
    s_mov_b64 exec, 1
    ds_add_u32 v2, v3 offset:4
    s_mov_b64 exec, -1
    s_and_b32 s60, s2, 7
    s_lshr_b32 s61, s2, 3
    s_lshr_b32 s62, s61, 3
    s_lshl_b32 s96, s60, 2
    s_add_u32 s96, s96, s62
    s_add_u32 s97, s61, 0
    s_and_b32 s97, s97, 7
    s_lshl_b32 s60, s96, 16
    s_lshl_b32 s61, s97, 7
    s_add_u32 s60, s60, s61
    s_lshl_b32 s61, s52, 4
    s_add_u32 s60, s60, s61
    v_lshlrev_b32 v240, 10, v0
    buffer_load_dwordx4 v[232:235], v240, s[36:39], s60 offen
    buffer_load_dwordx4 v[236:239], v240, s[36:39], s60 offen offset:64
    buffer_load_dwordx4 v[64:67], v156, s[40:43], s44 offen sc1
    buffer_load_dwordx4 v[68:71], v156, s[40:43], s45 offen sc1
    buffer_load_dwordx4 v[72:75], v156, s[40:43], s46 offen sc1
    buffer_load_dwordx4 v[76:79], v156, s[40:43], s47 offen sc1
    v_mfma_f32_16x16x32_bf16 v[224:227], v[192:195], v[160:163], 0
    v_mfma_f32_16x16x32_bf16 v[228:231], v[196:199], v[164:167], 0
    v_mfma_f32_16x16x32_bf16 v[224:227], v[200:203], v[168:171], v[224:227]
    v_mfma_f32_16x16x32_bf16 v[228:231], v[204:207], v[172:175], v[228:231]
    v_mfma_f32_16x16x32_bf16 v[224:227], v[208:211], v[176:179], v[224:227]
    v_mfma_f32_16x16x32_bf16 v[228:231], v[212:215], v[180:183], v[228:231]
    v_mfma_f32_16x16x32_bf16 v[224:227], v[216:219], v[184:187], v[224:227]
    v_mfma_f32_16x16x32_bf16 v[228:231], v[220:223], v[188:191], v[228:231]
    s_nop 7
    v_add_f32 v224, v224, v228
    v_add_f32 v225, v225, v229
    v_add_f32 v226, v226, v230
    v_add_f32 v227, v227, v231
    s_cmp_eq_u32 s54, 1
    s_cbranch_scc1 Lk1_1056
    v_cvt_pk_bf16_f32 v6, v227, v226
    v_cvt_pk_bf16_f32 v7, v225, v224
    v_mov_b32 v8, 0
    v_mov_b32 v9, 0
    v_mov_b32 v10, 0
    v_mov_b32 v11, 0
    s_add_u32 s60, s59, 4096
    v_add_u32 v12, s60, v1
    s_mov_b64 exec, 0x3fffffff
    ds_write_b128 v12, v[8:11]
    s_mov_b64 exec, -1
    s_branch Lk1d_1057
Lk1_1056:
    v_cvt_pk_bf16_f32 v6, v226, v225
    v_cvt_pk_bf16_f32 v7, v224, v224
Lk1d_1057:
    ds_write_b64 v154, v[6:7]
    s_mov_b32 s94, 65536
Lw_1058:
    ds_read_b32 v4, v2 offset:4
    s_waitcnt lgkmcnt(0)
    v_cmp_gt_u32 vcc, 12, v4
    s_cbranch_vccz Lwd_1059
    s_sub_u32 s94, s94, 1
    s_cbranch_scc0 Lw_1058
Lwd_1059:
    ds_write_b32 v150, v128 offset:8704
    ds_write_b32 v150, v129 offset:9248
    ds_write_b32 v150, v130 offset:9792
    ds_write_b32 v150, v131 offset:10336
    ds_write_b32 v150, v132 offset:10880
    ds_write_b32 v150, v133 offset:11424
    ds_write_b32 v150, v134 offset:11968
    ds_write_b32 v150, v135 offset:12512
    ds_write_b32 v150, v136 offset:13056
    ds_write_b32 v150, v137 offset:13600
    ds_write_b32 v150, v138 offset:14144
    ds_write_b32 v150, v139 offset:14688
    ds_write_b32 v150, v140 offset:15232
    ds_write_b32 v150, v141 offset:15776
    ds_write_b32 v150, v142 offset:16320
    ds_write_b32 v150, v143 offset:16864
    ds_write_b32 v150, v144 offset:17408
    ds_write_b32 v150, v145 offset:17952
    ds_write_b32 v150, v146 offset:18496
    ds_write_b32 v150, v147 offset:19040
    ds_write_b32 v150, v148 offset:19584
    ds_write_b32 v150, v149 offset:20128
    s_waitcnt lgkmcnt(0)
    s_mov_b64 exec, 1
    ds_add_u32 v2, v3 offset:4
    s_mov_b64 exec, -1
    s_mov_b32 s94, 65536
Lw_1060:
    ds_read_b32 v4, v2 offset:4
    s_waitcnt lgkmcnt(0)
    v_cmp_gt_u32 vcc, 16, v4
    s_cbranch_vccz Lwd_1061
    s_sub_u32 s94, s94, 1
    s_cbranch_scc0 Lw_1060
Lwd_1061:
    ds_read_b128 v[192:195], v153 offset:0
    ds_read_b128 v[196:199], v153 offset:64
    ds_read_b128 v[200:203], v153 offset:128
    ds_read_b128 v[204:207], v153 offset:192
    ds_read_b128 v[208:211], v153 offset:256
    ds_read_b128 v[212:215], v153 offset:320
    ds_read_b128 v[216:219], v153 offset:384
    ds_read_b128 v[220:223], v153 offset:448
    s_waitcnt lgkmcnt(0)
    v_mfma_f32_16x16x32_bf16 v[224:227], v[192:195], v[160:163], 0
    v_mfma_f32_16x16x32_bf16 v[228:231], v[196:199], v[164:167], 0
    v_mfma_f32_16x16x32_bf16 v[224:227], v[200:203], v[168:171], v[224:227]
    v_mfma_f32_16x16x32_bf16 v[228:231], v[204:207], v[172:175], v[228:231]
    v_mfma_f32_16x16x32_bf16 v[224:227], v[208:211], v[176:179], v[224:227]
    v_mfma_f32_16x16x32_bf16 v[228:231], v[212:215], v[180:183], v[228:231]
    v_mfma_f32_16x16x32_bf16 v[224:227], v[216:219], v[184:187], v[224:227]
    v_mfma_f32_16x16x32_bf16 v[228:231], v[220:223], v[188:191], v[228:231]
    s_nop 7
    v_add_f32 v224, v224, v228
    v_add_f32 v225, v225, v229
    v_add_f32 v226, v226, v230
    v_add_f32 v227, v227, v231
    s_cmp_eq_u32 s54, 1
    s_cbranch_scc1 Lk2_1062
    v_cvt_pk_bf16_f32 v8, v226, v226
    v_cvt_pk_bf16_f32 v9, v225, v225
    v_cvt_pk_bf16_f32 v10, v225, v224
    v_cvt_pk_bf16_f32 v11, v224, v224
    ds_write_b128 v155, v[8:11]
    s_branch Lk2d_1063
Lk2_1062:
    v_cvt_pk_bf16_f32 v8, v226, v226
    v_cvt_pk_bf16_f32 v10, v225, v225
    v_cvt_pk_bf16_f32 v13, v225, v224
    v_cvt_pk_bf16_f32 v14, v224, v224
    v_mov_b32 v9, v8
    v_mov_b32 v11, v10
    v_mov_b32 v12, v10
    v_mov_b32 v15, v14
    ds_write_b128 v155, v[8:11]
    ds_write_b128 v155, v[12:15] offset:16
Lk2d_1063:
    s_cmp_lg_u32 s52, 0
    s_cbranch_scc1 Lq0_1064
    v_mov_b32 v16, 0
    v_mov_b32 v17, 0
    v_mov_b32 v18, 0
    v_mov_b32 v19, 0
    v_add_u32 v6, -32, v157
    s_mov_b64 exec, 5
    ds_write_b128 v6, v[16:19]
    ds_write_b128 v6, v[16:19] offset:16
    ds_write_b128 v6, v[16:19] offset:4160
    ds_write_b128 v6, v[16:19] offset:4176
    ds_write_b16 v6, v16 offset:4192
    s_mov_b64 exec, -1
Lq0_1064:
    v_and_b32 v6, 15, v0
    v_lshrrev_b32 v7, 4, v0
    v_lshl_add_u32 v16, v7, 3, v6
    v_lshlrev_b32 v16, 1, v16
    v_and_b32 v17, 1, v6
    v_cmp_eq_u32 vcc, 0, v17
    v_mov_b32 v17, 4162
    s_nop 0
    v_cndmask_b32 v17, 0, v17, vcc
    v_add_u32 v16, v16, v17
    s_lshl_b32 s60, s54, 8
    s_add_u32 s63, s60, s57
    s_add_u32 s63, s63, 2
    v_add_u32 v20, s63, v16
    v_add_u32 v21, 1024, v20
    v_add_u32 v22, 2048, v20
    v_add_u32 v23, 3072, v20
    v_lshlrev_b32 v16, 4, v7
    v_lshlrev_b32 v17, 5, v6
    v_sub_u32 v16, v16, v17
    s_add_u32 s60, s60, s59
    s_add_u32 s60, s60, 480
    v_add_u32 v24, s60, v16
    s_waitcnt vmcnt(0)
    v_cmp_ne_u32 vcc, s35, v66
    v_cmp_ne_u32 s[90:91], s35, v70
    s_or_b64 vcc, vcc, s[90:91]
    v_cmp_ne_u32 s[90:91], s35, v74
    s_or_b64 vcc, vcc, s[90:91]
    v_cmp_ne_u32 s[90:91], s35, v78
    s_or_b64 vcc, vcc, s[90:91]
    s_cbranch_vccnz Lur_1065
Lurb_1066:
    ds_write_b64 v157, v[64:65] offset:0
    ds_write_b16 v157, v64 offset:4162
    v_alignbit_b32 v66, v65, v64, 16
    ds_write_b16_d16_hi v157, v65 offset:4168
    ds_write_b32 v157, v66 offset:4164
    ds_write_b64 v157, v[68:69] offset:256
    ds_write_b16 v157, v68 offset:4418
    v_alignbit_b32 v70, v69, v68, 16
    ds_write_b16_d16_hi v157, v69 offset:4424
    ds_write_b32 v157, v70 offset:4420
    ds_write_b64 v157, v[72:73] offset:512
    ds_write_b16 v157, v72 offset:4674
    v_alignbit_b32 v74, v73, v72, 16
    ds_write_b16_d16_hi v157, v73 offset:4680
    ds_write_b32 v157, v74 offset:4676
    ds_write_b64 v157, v[76:77] offset:768
    ds_write_b16 v157, v76 offset:4930
    v_alignbit_b32 v78, v77, v76, 16
    ds_write_b16_d16_hi v157, v77 offset:4936
    ds_write_b32 v157, v78 offset:4932
    s_waitcnt lgkmcnt(0)
    s_mov_b64 exec, 1
    ds_add_u32 v2, v3 offset:4
    s_mov_b64 exec, -1
    s_mov_b32 s94, 65536
Lw_1068:
    ds_read_b32 v4, v2 offset:4
    s_waitcnt lgkmcnt(0)
    v_cmp_gt_u32 vcc, 20, v4
    s_cbranch_vccz Lwd_1069
    s_sub_u32 s94, s94, 1
    s_cbranch_scc0 Lw_1068
Lwd_1069:
    s_or_b32 s60, s2, s52
    s_cmp_lg_u32 s60, 0
    s_cbranch_scc1 Lw0_1070
    v_mov_b32 v17, s35
    v_mov_b32 v16, 0
    s_mov_b64 exec, 1
    buffer_store_dword v17, v16, s[40:43], 0 offen
    s_mov_b64 exec, -1
Lw0_1070:
    ds_read_b128 v[96:99], v24 offset:3584
    ds_read2_b32 v[64:65], v20 offset0:0 offset1:1
    ds_read2_b32 v[66:67], v20 offset0:2 offset1:3
    ds_read_b128 v[100:103], v24 offset:3072
    ds_read2_b32 v[68:69], v20 offset0:128 offset1:129
    ds_read2_b32 v[70:71], v20 offset0:130 offset1:131
    ds_read_b128 v[104:107], v24 offset:2560
    ds_read2_b32 v[72:73], v21 offset0:0 offset1:1
    ds_read2_b32 v[74:75], v21 offset0:2 offset1:3
    ds_read_b128 v[108:111], v24 offset:2048
    ds_read2_b32 v[76:77], v21 offset0:128 offset1:129
    ds_read2_b32 v[78:79], v21 offset0:130 offset1:131
    ds_read_b128 v[112:115], v24 offset:1536
    ds_read2_b32 v[80:81], v22 offset0:0 offset1:1
    ds_read2_b32 v[82:83], v22 offset0:2 offset1:3
    ds_read_b128 v[116:119], v24 offset:1024
    ds_read2_b32 v[84:85], v22 offset0:128 offset1:129
    ds_read2_b32 v[86:87], v22 offset0:130 offset1:131
    ds_read_b128 v[120:123], v24 offset:512
    ds_read2_b32 v[88:89], v23 offset0:0 offset1:1
    ds_read2_b32 v[90:91], v23 offset0:2 offset1:3
    ds_read_b128 v[124:127], v24 offset:0
    ds_read2_b32 v[92:93], v23 offset0:128 offset1:129
    ds_read2_b32 v[94:95], v23 offset0:130 offset1:131
    s_waitcnt lgkmcnt(0)
    v_mfma_f32_16x16x32_bf16 v[32:35], v[64:67], v[96:99], 0
    ds_read_b128 v[160:163], v24 offset:3648
    v_mfma_f32_16x16x32_bf16 v[36:39], v[64:67], v[100:103], 0
    ds_read2_b32 v[128:129], v20 offset0:16 offset1:17
    v_mfma_f32_16x16x32_bf16 v[40:43], v[64:67], v[104:107], 0
    ds_read2_b32 v[130:131], v20 offset0:18 offset1:19
    v_mfma_f32_16x16x32_bf16 v[44:47], v[64:67], v[108:111], 0
    ds_read_b128 v[164:167], v24 offset:3136
    v_mfma_f32_16x16x32_bf16 v[48:51], v[64:67], v[112:115], 0
    ds_read2_b32 v[132:133], v20 offset0:144 offset1:145
    v_mfma_f32_16x16x32_bf16 v[52:55], v[64:67], v[116:119], 0
    ds_read2_b32 v[134:135], v20 offset0:146 offset1:147
    v_mfma_f32_16x16x32_bf16 v[56:59], v[64:67], v[120:123], 0
    ds_read_b128 v[168:171], v24 offset:2624
    v_mfma_f32_16x16x32_bf16 v[60:63], v[64:67], v[124:127], 0
    ds_read2_b32 v[136:137], v21 offset0:16 offset1:17
    v_mfma_f32_16x16x32_bf16 v[36:39], v[68:71], v[96:99], v[36:39]
    ds_read2_b32 v[138:139], v21 offset0:18 offset1:19
    v_mfma_f32_16x16x32_bf16 v[40:43], v[68:71], v[100:103], v[40:43]
    ds_read_b128 v[172:175], v24 offset:2112
    v_mfma_f32_16x16x32_bf16 v[44:47], v[68:71], v[104:107], v[44:47]
    ds_read2_b32 v[140:141], v21 offset0:144 offset1:145
    v_mfma_f32_16x16x32_bf16 v[48:51], v[68:71], v[108:111], v[48:51]
    ds_read2_b32 v[142:143], v21 offset0:146 offset1:147
    v_mfma_f32_16x16x32_bf16 v[52:55], v[68:71], v[112:115], v[52:55]
    ds_read_b128 v[176:179], v24 offset:1600
    v_mfma_f32_16x16x32_bf16 v[56:59], v[68:71], v[116:119], v[56:59]
    ds_read2_b32 v[144:145], v22 offset0:16 offset1:17
    v_mfma_f32_16x16x32_bf16 v[60:63], v[68:71], v[120:123], v[60:63]
    ds_read2_b32 v[146:147], v22 offset0:18 offset1:19
    v_mfma_f32_16x16x32_bf16 v[40:43], v[72:75], v[96:99], v[40:43]
    ds_read_b128 v[180:183], v24 offset:1088
    v_mfma_f32_16x16x32_bf16 v[44:47], v[72:75], v[100:103], v[44:47]
    ds_read2_b32 v[148:149], v22 offset0:144 offset1:145
    v_mfma_f32_16x16x32_bf16 v[48:51], v[72:75], v[104:107], v[48:51]
    ds_read2_b32 v[150:151], v22 offset0:146 offset1:147
    v_mfma_f32_16x16x32_bf16 v[52:55], v[72:75], v[108:111], v[52:55]
    ds_read_b128 v[184:187], v24 offset:576
    v_mfma_f32_16x16x32_bf16 v[56:59], v[72:75], v[112:115], v[56:59]
    ds_read2_b32 v[152:153], v23 offset0:16 offset1:17
    v_mfma_f32_16x16x32_bf16 v[60:63], v[72:75], v[116:119], v[60:63]
    ds_read2_b32 v[154:155], v23 offset0:18 offset1:19
    v_mfma_f32_16x16x32_bf16 v[44:47], v[76:79], v[96:99], v[44:47]
    ds_read_b128 v[188:191], v24 offset:64
    v_mfma_f32_16x16x32_bf16 v[48:51], v[76:79], v[100:103], v[48:51]
    ds_read2_b32 v[156:157], v23 offset0:144 offset1:145
    v_mfma_f32_16x16x32_bf16 v[52:55], v[76:79], v[104:107], v[52:55]
    ds_read2_b32 v[158:159], v23 offset0:146 offset1:147
    v_mfma_f32_16x16x32_bf16 v[56:59], v[76:79], v[108:111], v[56:59]
    v_mfma_f32_16x16x32_bf16 v[60:63], v[76:79], v[112:115], v[60:63]
    v_mfma_f32_16x16x32_bf16 v[48:51], v[80:83], v[96:99], v[48:51]
    v_mfma_f32_16x16x32_bf16 v[52:55], v[80:83], v[100:103], v[52:55]
    v_mfma_f32_16x16x32_bf16 v[56:59], v[80:83], v[104:107], v[56:59]
    v_mfma_f32_16x16x32_bf16 v[60:63], v[80:83], v[108:111], v[60:63]
    v_mfma_f32_16x16x32_bf16 v[52:55], v[84:87], v[96:99], v[52:55]
    v_mfma_f32_16x16x32_bf16 v[56:59], v[84:87], v[100:103], v[56:59]
    v_mfma_f32_16x16x32_bf16 v[60:63], v[84:87], v[104:107], v[60:63]
    v_mfma_f32_16x16x32_bf16 v[56:59], v[88:91], v[96:99], v[56:59]
    v_mfma_f32_16x16x32_bf16 v[60:63], v[88:91], v[100:103], v[60:63]
    v_mfma_f32_16x16x32_bf16 v[60:63], v[92:95], v[96:99], v[60:63]
    s_waitcnt lgkmcnt(0)
    v_mfma_f32_16x16x32_bf16 v[32:35], v[128:131], v[160:163], v[32:35]
    ds_read_b128 v[96:99], v24 offset:3712
    v_mfma_f32_16x16x32_bf16 v[36:39], v[128:131], v[164:167], v[36:39]
    ds_read2_b32 v[64:65], v20 offset0:32 offset1:33
    v_mfma_f32_16x16x32_bf16 v[40:43], v[128:131], v[168:171], v[40:43]
    ds_read2_b32 v[66:67], v20 offset0:34 offset1:35
    v_mfma_f32_16x16x32_bf16 v[44:47], v[128:131], v[172:175], v[44:47]
    ds_read_b128 v[100:103], v24 offset:3200
    v_mfma_f32_16x16x32_bf16 v[48:51], v[128:131], v[176:179], v[48:51]
    ds_read2_b32 v[68:69], v20 offset0:160 offset1:161
    v_mfma_f32_16x16x32_bf16 v[52:55], v[128:131], v[180:183], v[52:55]
    ds_read2_b32 v[70:71], v20 offset0:162 offset1:163
    v_mfma_f32_16x16x32_bf16 v[56:59], v[128:131], v[184:187], v[56:59]
    ds_read_b128 v[104:107], v24 offset:2688
    v_mfma_f32_16x16x32_bf16 v[60:63], v[128:131], v[188:191], v[60:63]
    ds_read2_b32 v[72:73], v21 offset0:32 offset1:33
    v_mfma_f32_16x16x32_bf16 v[36:39], v[132:135], v[160:163], v[36:39]
    ds_read2_b32 v[74:75], v21 offset0:34 offset1:35
    v_mfma_f32_16x16x32_bf16 v[40:43], v[132:135], v[164:167], v[40:43]
    ds_read_b128 v[108:111], v24 offset:2176
    v_mfma_f32_16x16x32_bf16 v[44:47], v[132:135], v[168:171], v[44:47]
    ds_read2_b32 v[76:77], v21 offset0:160 offset1:161
    v_mfma_f32_16x16x32_bf16 v[48:51], v[132:135], v[172:175], v[48:51]
    ds_read2_b32 v[78:79], v21 offset0:162 offset1:163
    v_mfma_f32_16x16x32_bf16 v[52:55], v[132:135], v[176:179], v[52:55]
    ds_read_b128 v[112:115], v24 offset:1664
    v_mfma_f32_16x16x32_bf16 v[56:59], v[132:135], v[180:183], v[56:59]
    ds_read2_b32 v[80:81], v22 offset0:32 offset1:33
    v_mfma_f32_16x16x32_bf16 v[60:63], v[132:135], v[184:187], v[60:63]
    ds_read2_b32 v[82:83], v22 offset0:34 offset1:35
    v_mfma_f32_16x16x32_bf16 v[40:43], v[136:139], v[160:163], v[40:43]
    ds_read_b128 v[116:119], v24 offset:1152
    v_mfma_f32_16x16x32_bf16 v[44:47], v[136:139], v[164:167], v[44:47]
    ds_read2_b32 v[84:85], v22 offset0:160 offset1:161
    v_mfma_f32_16x16x32_bf16 v[48:51], v[136:139], v[168:171], v[48:51]
    ds_read2_b32 v[86:87], v22 offset0:162 offset1:163
    v_mfma_f32_16x16x32_bf16 v[52:55], v[136:139], v[172:175], v[52:55]
    ds_read_b128 v[120:123], v24 offset:640
    v_mfma_f32_16x16x32_bf16 v[56:59], v[136:139], v[176:179], v[56:59]
    ds_read2_b32 v[88:89], v23 offset0:32 offset1:33
    v_mfma_f32_16x16x32_bf16 v[60:63], v[136:139], v[180:183], v[60:63]
    ds_read2_b32 v[90:91], v23 offset0:34 offset1:35
    v_mfma_f32_16x16x32_bf16 v[44:47], v[140:143], v[160:163], v[44:47]
    ds_read_b128 v[124:127], v24 offset:128
    v_mfma_f32_16x16x32_bf16 v[48:51], v[140:143], v[164:167], v[48:51]
    ds_read2_b32 v[92:93], v23 offset0:160 offset1:161
    v_mfma_f32_16x16x32_bf16 v[52:55], v[140:143], v[168:171], v[52:55]
    ds_read2_b32 v[94:95], v23 offset0:162 offset1:163
    v_mfma_f32_16x16x32_bf16 v[56:59], v[140:143], v[172:175], v[56:59]
    v_mfma_f32_16x16x32_bf16 v[60:63], v[140:143], v[176:179], v[60:63]
    v_mfma_f32_16x16x32_bf16 v[48:51], v[144:147], v[160:163], v[48:51]
    v_mfma_f32_16x16x32_bf16 v[52:55], v[144:147], v[164:167], v[52:55]
    v_mfma_f32_16x16x32_bf16 v[56:59], v[144:147], v[168:171], v[56:59]
    v_mfma_f32_16x16x32_bf16 v[60:63], v[144:147], v[172:175], v[60:63]
    v_mfma_f32_16x16x32_bf16 v[52:55], v[148:151], v[160:163], v[52:55]
    v_mfma_f32_16x16x32_bf16 v[56:59], v[148:151], v[164:167], v[56:59]
    v_mfma_f32_16x16x32_bf16 v[60:63], v[148:151], v[168:171], v[60:63]
    v_mfma_f32_16x16x32_bf16 v[56:59], v[152:155], v[160:163], v[56:59]
    v_mfma_f32_16x16x32_bf16 v[60:63], v[152:155], v[164:167], v[60:63]
    v_mfma_f32_16x16x32_bf16 v[60:63], v[156:159], v[160:163], v[60:63]
    s_waitcnt lgkmcnt(0)
    v_mfma_f32_16x16x32_bf16 v[32:35], v[64:67], v[96:99], v[32:35]
    ds_read_b128 v[160:163], v24 offset:3776
    v_mfma_f32_16x16x32_bf16 v[36:39], v[64:67], v[100:103], v[36:39]
    ds_read2_b32 v[128:129], v20 offset0:48 offset1:49
    v_mfma_f32_16x16x32_bf16 v[40:43], v[64:67], v[104:107], v[40:43]
    ds_read2_b32 v[130:131], v20 offset0:50 offset1:51
    v_mfma_f32_16x16x32_bf16 v[44:47], v[64:67], v[108:111], v[44:47]
    ds_read_b128 v[164:167], v24 offset:3264
    v_mfma_f32_16x16x32_bf16 v[48:51], v[64:67], v[112:115], v[48:51]
    ds_read2_b32 v[132:133], v20 offset0:176 offset1:177
    v_mfma_f32_16x16x32_bf16 v[52:55], v[64:67], v[116:119], v[52:55]
    ds_read2_b32 v[134:135], v20 offset0:178 offset1:179
    v_mfma_f32_16x16x32_bf16 v[56:59], v[64:67], v[120:123], v[56:59]
    ds_read_b128 v[168:171], v24 offset:2752
    v_mfma_f32_16x16x32_bf16 v[60:63], v[64:67], v[124:127], v[60:63]
    ds_read2_b32 v[136:137], v21 offset0:48 offset1:49
    v_mfma_f32_16x16x32_bf16 v[36:39], v[68:71], v[96:99], v[36:39]
    ds_read2_b32 v[138:139], v21 offset0:50 offset1:51
    v_mfma_f32_16x16x32_bf16 v[40:43], v[68:71], v[100:103], v[40:43]
    ds_read_b128 v[172:175], v24 offset:2240
    v_mfma_f32_16x16x32_bf16 v[44:47], v[68:71], v[104:107], v[44:47]
    ds_read2_b32 v[140:141], v21 offset0:176 offset1:177
    v_mfma_f32_16x16x32_bf16 v[48:51], v[68:71], v[108:111], v[48:51]
    ds_read2_b32 v[142:143], v21 offset0:178 offset1:179
    v_mfma_f32_16x16x32_bf16 v[52:55], v[68:71], v[112:115], v[52:55]
    ds_read_b128 v[176:179], v24 offset:1728
    v_mfma_f32_16x16x32_bf16 v[56:59], v[68:71], v[116:119], v[56:59]
    ds_read2_b32 v[144:145], v22 offset0:48 offset1:49
    v_mfma_f32_16x16x32_bf16 v[60:63], v[68:71], v[120:123], v[60:63]
    ds_read2_b32 v[146:147], v22 offset0:50 offset1:51
    v_mfma_f32_16x16x32_bf16 v[40:43], v[72:75], v[96:99], v[40:43]
    ds_read_b128 v[180:183], v24 offset:1216
    v_mfma_f32_16x16x32_bf16 v[44:47], v[72:75], v[100:103], v[44:47]
    ds_read2_b32 v[148:149], v22 offset0:176 offset1:177
    v_mfma_f32_16x16x32_bf16 v[48:51], v[72:75], v[104:107], v[48:51]
    ds_read2_b32 v[150:151], v22 offset0:178 offset1:179
    v_mfma_f32_16x16x32_bf16 v[52:55], v[72:75], v[108:111], v[52:55]
    ds_read_b128 v[184:187], v24 offset:704
    v_mfma_f32_16x16x32_bf16 v[56:59], v[72:75], v[112:115], v[56:59]
    ds_read2_b32 v[152:153], v23 offset0:48 offset1:49
    v_mfma_f32_16x16x32_bf16 v[60:63], v[72:75], v[116:119], v[60:63]
    ds_read2_b32 v[154:155], v23 offset0:50 offset1:51
    v_mfma_f32_16x16x32_bf16 v[44:47], v[76:79], v[96:99], v[44:47]
    ds_read_b128 v[188:191], v24 offset:192
    v_mfma_f32_16x16x32_bf16 v[48:51], v[76:79], v[100:103], v[48:51]
    ds_read2_b32 v[156:157], v23 offset0:176 offset1:177
    v_mfma_f32_16x16x32_bf16 v[52:55], v[76:79], v[104:107], v[52:55]
    ds_read2_b32 v[158:159], v23 offset0:178 offset1:179
    v_mfma_f32_16x16x32_bf16 v[56:59], v[76:79], v[108:111], v[56:59]
    v_mfma_f32_16x16x32_bf16 v[60:63], v[76:79], v[112:115], v[60:63]
    v_mfma_f32_16x16x32_bf16 v[48:51], v[80:83], v[96:99], v[48:51]
    v_mfma_f32_16x16x32_bf16 v[52:55], v[80:83], v[100:103], v[52:55]
    v_mfma_f32_16x16x32_bf16 v[56:59], v[80:83], v[104:107], v[56:59]
    v_mfma_f32_16x16x32_bf16 v[60:63], v[80:83], v[108:111], v[60:63]
    v_mfma_f32_16x16x32_bf16 v[52:55], v[84:87], v[96:99], v[52:55]
    v_mfma_f32_16x16x32_bf16 v[56:59], v[84:87], v[100:103], v[56:59]
    v_mfma_f32_16x16x32_bf16 v[60:63], v[84:87], v[104:107], v[60:63]
    v_mfma_f32_16x16x32_bf16 v[56:59], v[88:91], v[96:99], v[56:59]
    v_mfma_f32_16x16x32_bf16 v[60:63], v[88:91], v[100:103], v[60:63]
    v_mfma_f32_16x16x32_bf16 v[60:63], v[92:95], v[96:99], v[60:63]
    s_waitcnt lgkmcnt(0)
    v_mfma_f32_16x16x32_bf16 v[32:35], v[128:131], v[160:163], v[32:35]
    v_mfma_f32_16x16x32_bf16 v[36:39], v[128:131], v[164:167], v[36:39]
    v_mfma_f32_16x16x32_bf16 v[40:43], v[128:131], v[168:171], v[40:43]
    v_mfma_f32_16x16x32_bf16 v[44:47], v[128:131], v[172:175], v[44:47]
    v_mfma_f32_16x16x32_bf16 v[48:51], v[128:131], v[176:179], v[48:51]
    v_mfma_f32_16x16x32_bf16 v[52:55], v[128:131], v[180:183], v[52:55]
    v_mfma_f32_16x16x32_bf16 v[56:59], v[128:131], v[184:187], v[56:59]
    v_mfma_f32_16x16x32_bf16 v[60:63], v[128:131], v[188:191], v[60:63]
    v_mfma_f32_16x16x32_bf16 v[36:39], v[132:135], v[160:163], v[36:39]
    v_mfma_f32_16x16x32_bf16 v[40:43], v[132:135], v[164:167], v[40:43]
    v_mfma_f32_16x16x32_bf16 v[44:47], v[132:135], v[168:171], v[44:47]
    v_mfma_f32_16x16x32_bf16 v[48:51], v[132:135], v[172:175], v[48:51]
    v_mfma_f32_16x16x32_bf16 v[52:55], v[132:135], v[176:179], v[52:55]
    v_mfma_f32_16x16x32_bf16 v[56:59], v[132:135], v[180:183], v[56:59]
    v_mfma_f32_16x16x32_bf16 v[60:63], v[132:135], v[184:187], v[60:63]
    v_mfma_f32_16x16x32_bf16 v[40:43], v[136:139], v[160:163], v[40:43]
    v_mfma_f32_16x16x32_bf16 v[44:47], v[136:139], v[164:167], v[44:47]
    v_mfma_f32_16x16x32_bf16 v[48:51], v[136:139], v[168:171], v[48:51]
    v_mfma_f32_16x16x32_bf16 v[52:55], v[136:139], v[172:175], v[52:55]
    v_mfma_f32_16x16x32_bf16 v[56:59], v[136:139], v[176:179], v[56:59]
    v_mfma_f32_16x16x32_bf16 v[60:63], v[136:139], v[180:183], v[60:63]
    v_mfma_f32_16x16x32_bf16 v[44:47], v[140:143], v[160:163], v[44:47]
    v_mfma_f32_16x16x32_bf16 v[48:51], v[140:143], v[164:167], v[48:51]
    v_mfma_f32_16x16x32_bf16 v[52:55], v[140:143], v[168:171], v[52:55]
    v_mfma_f32_16x16x32_bf16 v[56:59], v[140:143], v[172:175], v[56:59]
    v_mfma_f32_16x16x32_bf16 v[60:63], v[140:143], v[176:179], v[60:63]
    v_mfma_f32_16x16x32_bf16 v[48:51], v[144:147], v[160:163], v[48:51]
    v_mfma_f32_16x16x32_bf16 v[52:55], v[144:147], v[164:167], v[52:55]
    v_mfma_f32_16x16x32_bf16 v[56:59], v[144:147], v[168:171], v[56:59]
    v_mfma_f32_16x16x32_bf16 v[60:63], v[144:147], v[172:175], v[60:63]
    v_mfma_f32_16x16x32_bf16 v[52:55], v[148:151], v[160:163], v[52:55]
    v_mfma_f32_16x16x32_bf16 v[56:59], v[148:151], v[164:167], v[56:59]
    v_mfma_f32_16x16x32_bf16 v[60:63], v[148:151], v[168:171], v[60:63]
    v_mfma_f32_16x16x32_bf16 v[56:59], v[152:155], v[160:163], v[56:59]
    v_mfma_f32_16x16x32_bf16 v[60:63], v[152:155], v[164:167], v[60:63]
    v_mfma_f32_16x16x32_bf16 v[60:63], v[156:159], v[160:163], v[60:63]
    s_setprio 3
    s_add_u32 s60, s57, 8704
    v_add_u32 v6, s60, v1
    s_cmp_eq_u32 s54, 1
    s_cbranch_scc1 Lx1_1071
    ds_write_b128 v6, v[48:51] offset:0
    ds_write_b128 v6, v[52:55] offset:1024
    ds_write_b128 v6, v[56:59] offset:2048
    ds_write_b128 v6, v[60:63] offset:3072
    v_add_u32 v6, 4096, v6
    s_branch Lx1d_1072
Lx1_1071:
    ds_write_b128 v6, v[32:35] offset:4096
    ds_write_b128 v6, v[36:39] offset:5120
    ds_write_b128 v6, v[40:43] offset:6144
    ds_write_b128 v6, v[44:47] offset:7168
    v_mov_b32 v32, v48
    v_mov_b32 v33, v49
    v_mov_b32 v34, v50
    v_mov_b32 v35, v51
    v_mov_b32 v36, v52
    v_mov_b32 v37, v53
    v_mov_b32 v38, v54
    v_mov_b32 v39, v55
    v_mov_b32 v40, v56
    v_mov_b32 v41, v57
    v_mov_b32 v42, v58
    v_mov_b32 v43, v59
    v_mov_b32 v44, v60
    v_mov_b32 v45, v61
    v_mov_b32 v46, v62
    v_mov_b32 v47, v63
Lx1d_1072:
    s_waitcnt lgkmcnt(0)
    s_mov_b64 exec, 1
    ds_add_u32 v2, v3 offset:4
    s_mov_b64 exec, -1
    v_and_b32 v7, 15, v0
    v_lshrrev_b32 v8, 4, v0
    v_lshlrev_b32 v9, 5, v7
    v_lshl_add_u32 v9, v8, 3, v9
    s_lshl_b32 s60, s54, 11
    s_add_u32 s61, s60, s57
    s_add_u32 s61, s61, 32
    v_add_u32 v9, s61, v9
    ds_read_b64 v[64:65], v9 offset:0
    ds_read_b64 v[66:67], v9 offset:512
    ds_read_b64 v[68:69], v9 offset:1024
    ds_read_b64 v[70:71], v9 offset:1536
    v_and_b32 v10, 3, v0
    v_lshlrev_b32 v10, 6, v10
    v_and_b32 v11, 0x3c, v0
    v_or_b32 v10, v10, v11
    s_lshl_b32 s61, s53, 13
    s_lshl_b32 s60, s54, 12
    s_add_u32 s61, s61, s60
    s_add_u32 s61, s61, 5767168
    s_waitcnt lgkmcnt(0)
    v_lshlrev_b32 v72, 16, v64
    v_and_b32 v73, 0xffff0000, v64
    v_lshlrev_b32 v74, 16, v65
    v_and_b32 v75, 0xffff0000, v65
    v_lshlrev_b32 v76, 16, v66
    v_and_b32 v77, 0xffff0000, v66
    v_lshlrev_b32 v78, 16, v67
    v_and_b32 v79, 0xffff0000, v67
    v_lshlrev_b32 v80, 16, v68
    v_and_b32 v81, 0xffff0000, v68
    v_lshlrev_b32 v82, 16, v69
    v_and_b32 v83, 0xffff0000, v69
    v_lshlrev_b32 v84, 16, v70
    v_and_b32 v85, 0xffff0000, v70
    v_lshlrev_b32 v86, 16, v71
    v_and_b32 v87, 0xffff0000, v71
    v_mul_f32 v72, s56, v72
    v_mul_f32 v73, s56, v73
    v_mul_f32 v74, s56, v74
    v_mul_f32 v75, s56, v75
    v_mul_f32 v76, s56, v76
    v_mul_f32 v77, s56, v77
    v_mul_f32 v78, s56, v78
    v_mul_f32 v79, s56, v79
    v_mul_f32 v80, s56, v80
    v_mul_f32 v81, s56, v81
    v_mul_f32 v82, s56, v82
    v_mul_f32 v83, s56, v83
    v_mul_f32 v84, s56, v84
    v_mul_f32 v85, s56, v85
    v_mul_f32 v86, s56, v86
    v_mul_f32 v87, s56, v87
    v_cvt_pk_bf16_f32 v64, v72, v73
    v_cvt_pk_bf16_f32 v65, v74, v75
    v_cvt_pk_bf16_f32 v66, v76, v77
    v_cvt_pk_bf16_f32 v67, v78, v79
    v_cvt_pk_bf16_f32 v68, v80, v81
    v_cvt_pk_bf16_f32 v69, v82, v83
    v_cvt_pk_bf16_f32 v70, v84, v85
    v_cvt_pk_bf16_f32 v71, v86, v87
    v_lshlrev_b32 v72, 16, v64
    v_and_b32 v73, 0xffff0000, v64
    v_lshlrev_b32 v74, 16, v65
    v_and_b32 v75, 0xffff0000, v65
    v_lshlrev_b32 v76, 16, v66
    v_and_b32 v77, 0xffff0000, v66
    v_lshlrev_b32 v78, 16, v67
    v_and_b32 v79, 0xffff0000, v67
    v_lshlrev_b32 v80, 16, v68
    v_and_b32 v81, 0xffff0000, v68
    v_lshlrev_b32 v82, 16, v69
    v_and_b32 v83, 0xffff0000, v69
    v_lshlrev_b32 v84, 16, v70
    v_and_b32 v85, 0xffff0000, v70
    v_lshlrev_b32 v86, 16, v71
    v_and_b32 v87, 0xffff0000, v71
    s_mov_b32 s94, 65536
Lw_1073:
    ds_read_b32 v4, v2 offset:4
    s_waitcnt lgkmcnt(0)
    v_cmp_gt_u32 vcc, 24, v4
    s_cbranch_vccz Lwd_1074
    s_sub_u32 s94, s94, 1
    s_cbranch_scc0 Lw_1073
Lwd_1074:
    ds_read_b128 v[96:99], v6 offset:0
    ds_read_b128 v[100:103], v6 offset:1024
    ds_read_b128 v[104:107], v6 offset:2048
    ds_read_b128 v[108:111], v6 offset:3072
    s_waitcnt lgkmcnt(0)
    v_add_f32 v32, v32, v96
    v_add_f32 v33, v33, v97
    v_add_f32 v34, v34, v98
    v_add_f32 v35, v35, v99
    v_add_f32 v36, v36, v100
    v_add_f32 v37, v37, v101
    v_add_f32 v38, v38, v102
    v_add_f32 v39, v39, v103
    v_add_f32 v40, v40, v104
    v_add_f32 v41, v41, v105
    v_add_f32 v42, v42, v106
    v_add_f32 v43, v43, v107
    v_add_f32 v44, v44, v108
    v_add_f32 v45, v45, v109
    v_add_f32 v46, v46, v110
    v_add_f32 v47, v47, v111
    v_cvt_pk_bf16_f32 v64, v32, v33
    v_cvt_pk_bf16_f32 v65, v34, v35
    v_cvt_pk_bf16_f32 v66, v36, v37
    v_cvt_pk_bf16_f32 v67, v38, v39
    v_cvt_pk_bf16_f32 v68, v40, v41
    v_cvt_pk_bf16_f32 v69, v42, v43
    v_cvt_pk_bf16_f32 v70, v44, v45
    v_cvt_pk_bf16_f32 v71, v46, v47
    v_lshlrev_b32 v32, 16, v64
    v_and_b32 v33, 0xffff0000, v64
    v_lshlrev_b32 v34, 16, v65
    v_and_b32 v35, 0xffff0000, v65
    v_lshlrev_b32 v36, 16, v66
    v_and_b32 v37, 0xffff0000, v66
    v_lshlrev_b32 v38, 16, v67
    v_and_b32 v39, 0xffff0000, v67
    v_lshlrev_b32 v40, 16, v68
    v_and_b32 v41, 0xffff0000, v68
    v_lshlrev_b32 v42, 16, v69
    v_and_b32 v43, 0xffff0000, v69
    v_lshlrev_b32 v44, 16, v70
    v_and_b32 v45, 0xffff0000, v70
    v_lshlrev_b32 v46, 16, v71
    v_and_b32 v47, 0xffff0000, v71
    v_add_f32 v32, v32, v72
    v_add_f32 v33, v33, v73
    v_add_f32 v34, v34, v74
    v_add_f32 v35, v35, v75
    v_add_f32 v36, v36, v76
    v_add_f32 v37, v37, v77
    v_add_f32 v38, v38, v78
    v_add_f32 v39, v39, v79
    v_add_f32 v40, v40, v80
    v_add_f32 v41, v41, v81
    v_add_f32 v42, v42, v82
    v_add_f32 v43, v43, v83
    v_add_f32 v44, v44, v84
    v_add_f32 v45, v45, v85
    v_add_f32 v46, v46, v86
    v_add_f32 v47, v47, v87
    v_cvt_pk_bf16_f32 v64, v32, v33
    v_cvt_pk_bf16_f32 v65, v34, v35
    v_cvt_pk_bf16_f32 v66, v36, v37
    v_cvt_pk_bf16_f32 v67, v38, v39
    v_cvt_pk_bf16_f32 v68, v40, v41
    v_cvt_pk_bf16_f32 v69, v42, v43
    v_cvt_pk_bf16_f32 v70, v44, v45
    v_cvt_pk_bf16_f32 v71, v46, v47
    ds_bpermute_b32 v96, v10, v64
    ds_bpermute_b32 v97, v10, v65
    v_mov_b32 v98, s35
    v_mov_b32 v99, s35
    ds_bpermute_b32 v100, v10, v66
    ds_bpermute_b32 v101, v10, v67
    v_mov_b32 v102, s35
    v_mov_b32 v103, s35
    ds_bpermute_b32 v104, v10, v68
    ds_bpermute_b32 v105, v10, v69
    v_mov_b32 v106, s35
    v_mov_b32 v107, s35
    ds_bpermute_b32 v108, v10, v70
    ds_bpermute_b32 v109, v10, v71
    v_mov_b32 v110, s35
    v_mov_b32 v111, s35
    s_waitcnt lgkmcnt(6)
    buffer_store_dwordx4 v[96:99], v1, s[40:43], s61 offen offset:0 sc1
    s_waitcnt lgkmcnt(4)
    buffer_store_dwordx4 v[100:103], v1, s[40:43], s61 offen offset:1024 sc1
    s_waitcnt lgkmcnt(2)
    buffer_store_dwordx4 v[104:107], v1, s[40:43], s61 offen offset:2048 sc1
    s_waitcnt lgkmcnt(0)
    buffer_store_dwordx4 v[108:111], v1, s[40:43], s61 offen offset:3072 sc1
    v_lshrrev_b32 v8, 4, v0
    v_and_b32 v9, 15, v0
    v_lshlrev_b32 v8, 13, v8
    v_lshl_add_u32 v8, v9, 4, v8
    v_and_b32 v9, 7, v0
    s_lshl_b32 s61, s97, 19
    s_lshl_b32 s62, s52, 16
    s_add_u32 s61, s61, s62
    s_lshl_b32 s62, s96, 8
    s_add_u32 s61, s61, s62
    s_add_u32 s44, s61, 5767168
    s_add_u32 s45, s44, 32768
    s_add_u32 s46, s61, 6029312
    s_add_u32 s47, s46, 32768
    s_lshl_b32 s62, s52, 11
    s_add_u32 s100, s62, 153216
    v_lshl_add_u32 v7, v0, 3, s100
    v_bfe_u32 v10, v0, 2, 2
    v_lshlrev_b32 v10, 7, v10
    v_lshrrev_b32 v11, 4, v0
    v_lshl_add_u32 v10, v11, 5, v10
    v_and_b32 v11, 3, v0
    v_lshl_add_u32 v10, v11, 3, v10
    v_add_u32 v10, s100, v10
    v_xor_b32 v11, s52, v9
    v_lshlrev_b32 v11, 4, v11
    v_lshl_add_u32 v11, v0, 7, v11
    v_add_u32 v11, 142976, v11
    v_xor_b32 v12, 64, v11
    s_waitcnt vmcnt(4)
    v_lshlrev_b32 v16, 16, v232
    v_and_b32 v17, 0xffff0000, v232
    v_lshlrev_b32 v18, 16, v233
    v_and_b32 v19, 0xffff0000, v233
    v_lshlrev_b32 v20, 16, v234
    v_and_b32 v21, 0xffff0000, v234
    v_lshlrev_b32 v22, 16, v235
    v_and_b32 v23, 0xffff0000, v235
    v_lshlrev_b32 v24, 16, v236
    v_and_b32 v25, 0xffff0000, v236
    v_lshlrev_b32 v26, 16, v237
    v_and_b32 v27, 0xffff0000, v237
    v_lshlrev_b32 v28, 16, v238
    v_and_b32 v29, 0xffff0000, v238
    v_lshlrev_b32 v30, 16, v239
    v_and_b32 v31, 0xffff0000, v239
    s_mov_b32 s94, 65536
Lw_1075:
    ds_read_b32 v4, v2 offset:8
    s_waitcnt lgkmcnt(0)
    v_cmp_gt_u32 vcc, 4, v4
    s_cbranch_vccz Lwd_1076
    s_sleep 4
    s_sub_u32 s94, s94, 1
    s_cbranch_scc0 Lw_1075
Lwd_1076:
    buffer_load_dwordx4 v[64:67], v8, s[40:43], s44 offen sc1
    buffer_load_dwordx4 v[68:71], v8, s[40:43], s45 offen sc1
    buffer_load_dwordx4 v[72:75], v8, s[40:43], s46 offen sc1
    buffer_load_dwordx4 v[76:79], v8, s[40:43], s47 offen sc1
    s_waitcnt vmcnt(0)
    v_cmp_ne_u32 vcc, s35, v66
    v_cmp_ne_u32 s[90:91], s35, v70
    s_or_b64 vcc, vcc, s[90:91]
    v_cmp_ne_u32 s[90:91], s35, v74
    s_or_b64 vcc, vcc, s[90:91]
    v_cmp_ne_u32 s[90:91], s35, v78
    s_or_b64 vcc, vcc, s[90:91]
    s_cbranch_vccnz Lar_1077
Larb_1078:
    ds_write_b64 v7, v[64:65] offset:0
    ds_write_b64 v7, v[68:69] offset:512
    ds_write_b64 v7, v[72:73] offset:1024
    ds_write_b64 v7, v[76:77] offset:1536
    s_waitcnt lgkmcnt(0)
    ds_read_b64_tr_b16 v[32:33], v10 offset:0
    ds_read_b64_tr_b16 v[34:35], v10 offset:512
    ds_read_b64_tr_b16 v[36:37], v10 offset:1024
    ds_read_b64_tr_b16 v[38:39], v10 offset:1536
    s_waitcnt lgkmcnt(2)
    v_lshlrev_b32 v40, 16, v32
    v_and_b32 v41, 0xffff0000, v32
    v_lshlrev_b32 v42, 16, v33
    v_and_b32 v43, 0xffff0000, v33
    v_lshlrev_b32 v44, 16, v34
    v_and_b32 v45, 0xffff0000, v34
    v_lshlrev_b32 v46, 16, v35
    v_and_b32 v47, 0xffff0000, v35
    v_add_f32 v16, v16, v40
    v_add_f32 v17, v17, v41
    v_add_f32 v18, v18, v42
    v_add_f32 v19, v19, v43
    v_add_f32 v20, v20, v44
    v_add_f32 v21, v21, v45
    v_add_f32 v22, v22, v46
    v_add_f32 v23, v23, v47
    v_cvt_pk_bf16_f32 v56, v16, v17
    v_cvt_pk_bf16_f32 v57, v18, v19
    v_cvt_pk_bf16_f32 v58, v20, v21
    v_cvt_pk_bf16_f32 v59, v22, v23
    s_waitcnt lgkmcnt(0)
    v_lshlrev_b32 v48, 16, v36
    v_and_b32 v49, 0xffff0000, v36
    v_lshlrev_b32 v50, 16, v37
    v_and_b32 v51, 0xffff0000, v37
    v_lshlrev_b32 v52, 16, v38
    v_and_b32 v53, 0xffff0000, v38
    v_lshlrev_b32 v54, 16, v39
    v_and_b32 v55, 0xffff0000, v39
    v_add_f32 v24, v24, v48
    v_add_f32 v25, v25, v49
    v_add_f32 v26, v26, v50
    v_add_f32 v27, v27, v51
    v_add_f32 v28, v28, v52
    v_add_f32 v29, v29, v53
    v_add_f32 v30, v30, v54
    v_add_f32 v31, v31, v55
    v_cvt_pk_bf16_f32 v60, v24, v25
    v_cvt_pk_bf16_f32 v61, v26, v27
    v_cvt_pk_bf16_f32 v62, v28, v29
    v_cvt_pk_bf16_f32 v63, v30, v31
    ds_write_b128 v11, v[56:59]
    ds_write_b128 v12, v[60:63]
    s_waitcnt lgkmcnt(0)
    s_mov_b64 exec, 1
    ds_add_u32 v2, v3 offset:12
    s_mov_b64 exec, -1
    s_endpgm
Lur_1065:
    s_mov_b32 s94, 65536
Lurl_1067:
    s_sleep 8
    buffer_load_dwordx4 v[64:67], v156, s[40:43], s44 offen sc1
    buffer_load_dwordx4 v[68:71], v156, s[40:43], s45 offen sc1
    buffer_load_dwordx4 v[72:75], v156, s[40:43], s46 offen sc1
    buffer_load_dwordx4 v[76:79], v156, s[40:43], s47 offen sc1
    s_waitcnt vmcnt(0)
    v_cmp_ne_u32 vcc, s35, v66
    v_cmp_ne_u32 s[90:91], s35, v70
    s_or_b64 vcc, vcc, s[90:91]
    v_cmp_ne_u32 s[90:91], s35, v74
    s_or_b64 vcc, vcc, s[90:91]
    v_cmp_ne_u32 s[90:91], s35, v78
    s_or_b64 vcc, vcc, s[90:91]
    s_cbranch_vccz Lurb_1066
    s_sub_u32 s94, s94, 1
    s_cbranch_scc0 Lurl_1067
    s_branch Lurb_1066
Lar_1077:
    s_mov_b32 s94, 65536
Larl_1079:
    s_sleep 8
    buffer_load_dwordx4 v[64:67], v8, s[40:43], s44 offen sc1
    buffer_load_dwordx4 v[68:71], v8, s[40:43], s45 offen sc1
    buffer_load_dwordx4 v[72:75], v8, s[40:43], s46 offen sc1
    buffer_load_dwordx4 v[76:79], v8, s[40:43], s47 offen sc1
    s_waitcnt vmcnt(0)
    v_cmp_ne_u32 vcc, s35, v66
    v_cmp_ne_u32 s[90:91], s35, v70
    s_or_b64 vcc, vcc, s[90:91]
    v_cmp_ne_u32 s[90:91], s35, v74
    s_or_b64 vcc, vcc, s[90:91]
    v_cmp_ne_u32 s[90:91], s35, v78
    s_or_b64 vcc, vcc, s[90:91]
    s_cbranch_vccz Larb_1078
    s_sub_u32 s94, s94, 1
    s_cbranch_scc0 Larl_1079
    s_branch Larb_1078
Lend1:
    s_endpgm
.section .rodata,"a"
.p2align 6
.amdhsa_kernel parallel_sum__ssm_conv_s4d__mixer_channel_mlp__prompt_kernel
  .amdhsa_next_free_vgpr 256
  .amdhsa_next_free_sgpr 102
  .amdhsa_accum_offset 256
  .amdhsa_group_segment_fixed_size 0
  .amdhsa_kernarg_size 120
  .amdhsa_user_sgpr_count 2
  .amdhsa_user_sgpr_kernarg_segment_ptr 1
  .amdhsa_system_sgpr_workgroup_id_x 1
.end_amdhsa_kernel
```
